```python
import torch

def _softmax(x, axis=-1):
    return torch.softmax(x, dim=axis)
def _gelu(x):
    return torch.nn.functional.gelu(x, approximate="tanh")
def _silu(x):
    return torch.nn.functional.silu(x)
def _sigmoid(x):
    return torch.sigmoid(x)
def _layernorm(x, axis=-1, eps=1e-5):
    m = x.mean(dim=axis, keepdim=True)
    v = x.var(dim=axis, keepdim=True, unbiased=False)
    return (x - m) / torch.sqrt(v + eps)
def _scatter_add(tgt, idx, src, axis=0):
    return tgt.clone().index_add_(axis, idx, src)
def _segment_sum(src, seg, n):
    out = torch.zeros((n,) + src.shape[1:], dtype=src.dtype)
    return out.index_add_(0, seg, src)
def _pad(x, pw):
    flat = tuple(v for pair in reversed(pw) for v in pair)
    return torch.nn.functional.pad(x, flat)

kernel_name = 'parallel_sum__ssm_conv_s4__dense_activation_squared_relu__prompt'

def setup_inputs():

    _w = (lambda a: (lambda t: t.to(torch.bfloat16) if t.is_floating_point() else t)(torch.as_tensor(a)))
    def _A_setup():
        B, L, D, N = 1, 2048, 448, 256
        A_re = -(lambda _x: torch.exp(torch.as_tensor(_x)))((lambda *s: torch.randn(*s, dtype=torch.bfloat16) * 3.2)(D, N))
        A_im = torch.pi * (lambda *s: torch.randn(*s, dtype=torch.bfloat16) * 0.2)(D, N)
        B_re = (lambda *s: torch.randn(*s, dtype=torch.bfloat16) * 0.4)(D, N)
        B_im = (lambda *s: torch.randn(*s, dtype=torch.bfloat16) * 0.4)(D, N)
        C_re = (lambda *s: torch.randn(*s, dtype=torch.bfloat16) * 0.4)(D, N)
        C_im = (lambda *s: torch.randn(*s, dtype=torch.bfloat16) * 0.4)(D, N)
        log_dt = (lambda *s: torch.randn(*s, dtype=torch.bfloat16) * 0.2)(D) * 0.5 - 4.0
        Dskip = (lambda *s: torch.randn(*s, dtype=torch.bfloat16) * 0.4)(D)
        return {
            "u": _w((lambda *s: torch.randn(*s, dtype=torch.bfloat16) * 0.05)(B, L, D)),
            "A_re": _w(A_re),
            "A_im": _w(A_im),
            "B_re": _w(B_re),
            "B_im": _w(B_im),
            "C_re": _w(C_re),
            "C_im": _w(C_im),
            "log_dt": _w(log_dt),
            "Dskip": _w(Dskip),
        }
    _A_in = _A_setup()

    def _B_setup():
        B, S, D, F = 1, 2048, 448, 1792
        return {
            "x": _w((lambda *s: torch.randn(*s, dtype=torch.bfloat16) * 0.05)(B, S, D)),
            "w1": _w((lambda *s: torch.randn(*s, dtype=torch.bfloat16) * 0.05)(D, F)),
            "b1": _w((lambda *s: torch.randn(*s, dtype=torch.bfloat16) * 0.2)(F)),
            "w2": _w((lambda *s: torch.randn(*s, dtype=torch.bfloat16) * 0.05)(F, D)),
            "b2": _w((lambda *s: torch.randn(*s, dtype=torch.bfloat16) * 0.8)(D)),
        }
    _B_in = _B_setup()

    return {
        "A_u": _A_in["u"],
        "A_A_re": _A_in["A_re"],
        "A_A_im": _A_in["A_im"],
        "A_B_re": _A_in["B_re"],
        "A_B_im": _A_in["B_im"],
        "A_C_re": _A_in["C_re"],
        "A_C_im": _A_in["C_im"],
        "A_log_dt": _A_in["log_dt"],
        "A_Dskip": _A_in["Dskip"],
        "B_x": _B_in["x"],
        "B_w1": _B_in["w1"],
        "B_b1": _B_in["b1"],
        "B_w2": _B_in["w2"],
        "B_b2": _B_in["b2"],
    }

def reference(A_u, A_A_re, A_A_im, A_B_re, A_B_im, A_C_re, A_C_im, A_log_dt, A_Dskip, B_x, B_w1, B_b1, B_w2, B_b2):
    def _A_ref(u, A_re, A_im, B_re, B_im, C_re, C_im, log_dt, Dskip):
        Bsz, L, D = u.shape
        dt = torch.exp(log_dt)[:, None]
        A = A_re + 1j * A_im
        Bc = B_re + 1j * B_im
        Cc = C_re + 1j * C_im
        logdA = dt * A
        dB = dt * Bc
        l = (lambda x, dt: x.to(dt))(torch.arange(L), A_re.dtype)
        P = torch.exp(logdA[:, :, None] * l[None, None, :])
        K = torch.einsum("dn,dnl,dn->dl", Cc, P, dB).real
        L2 = 2 * L
        Kp = _pad(K, ((0, 0), (0, L)))
        up = (lambda x, *d: x.permute(*d))(u, 0, 2, 1)
        up = _pad(up, ((0, 0), (0, 0), (0, L)))
        Kf = (lambda x, axes=(-2,-1): torch.fft.rfft2(x.float(), dim=axes))(Kp[:, None, :], axes=(-2, -1))
        Uf = (lambda x, axes=(-2,-1): torch.fft.rfft2(x.float(), dim=axes))(up[:, :, None, :], axes=(-2, -1))
        Yf = Uf * Kf[None, :, :, :]
        y = (lambda x, s, axes=(-2,-1): torch.fft.irfft2(x, s=s, dim=axes).to(torch.bfloat16))(Yf, (1, L2), axes=(-2, -1))[:, :, 0, :L]
        y = (lambda x, *d: x.permute(*d))(y, 0, 2, 1) + u * Dskip[None, None, :]
        return y

    def _B_ref(x, w1, b1, w2, b2):
        h = torch.einsum("bsd,df->bsf", x, w1) + b1
        zero = torch.zeros_like(h)
        r = torch.where(h > zero, h, zero)
        h = r * r
        out = torch.einsum("bsf,fd->bsd", h, w2) + b2
        return out

    x = A_u
    xn = _layernorm(x, axis=-1)
    return x + _A_ref(xn, A_A_re, A_A_im, A_B_re, A_B_im, A_C_re, A_C_im, A_log_dt, A_Dskip) + _B_ref(xn, B_w1, B_b1, B_w2, B_b2)
```

```asm
; @launch grid=(256,1,1) block=(512,1,1) lds=163840
.amdgcn_target "amdgcn-amd-amdhsa--gfx950"
.text
.globl parallel_sum__ssm_conv_s4__dense_activation_squared_relu__prompt_kernel
.p2align 8
.type parallel_sum__ssm_conv_s4__dense_activation_squared_relu__prompt_kernel,@function
parallel_sum__ssm_conv_s4__dense_activation_squared_relu__prompt_kernel:
L_entry:
  s_cmp_ge_u32 s2, 256
  s_cbranch_scc1 L_end
  s_load_dwordx16 s[16:31], s[0:1], 0
  s_load_dwordx16 s[32:47], s[0:1], 64
  s_load_dwordx2 s[48:49], s[0:1], 128
  s_getpc_b64 s[12:13]
L_pc:
  v_lshrrev_b32_e64 v2, 6, v0
  v_and_b32 v1, 1, v0
  s_lshl_b32 s8, s2, 4
  v_lshl_add_u32 v1, v1, 3, v2
  s_and_b32 s8, s8, 0xf80
  v_lshl_add_u32 v1, v1, 12, s8
  v_min_u32 v1, L_codeend-L_pc-4, v1
  global_load_dword v11, v1, s[12:13]
  v_and_b32 v1, 63, v0
  v_mov_b32 v14, 0
  v_readfirstlane_b32 s74, v2
  v_lshlrev_b32 v2, 2, v1
  v_and_b32 v2, 0x7c, v2
  ds_write_b32 v2, v14 offset:49024
  ds_write_b32 v2, v14 offset:28672
  ds_write_b32 v2, v14 offset:28800
  v_mov_b32 v15, 1
  s_and_b32 s4, s2, 7
  s_and_b32 s3, s74, 3
  s_lshr_b32 s5, s2, 3
  s_mul_i32 s6, s5, 37
  s_lshr_b32 s6, s6, 8
  s_mul_i32 s7, s6, 7
  s_sub_u32 s7, s5, s7
  s_lshr_b32 s8, s4, 1
  s_lshl_b32 s67, s8, 2
  s_add_u32 s67, s67, s6
  s_and_b32 s8, s4, 1
  s_mul_i32 s68, s8, 7
  s_add_u32 s68, s68, s7
  s_mul_i32 s71, s6, 0
  s_lshl_b32 s69, s4, 2
  s_add_u32 s69, s69, s6
  s_mul_i32 s70, s4, 56
  s_lshl_b32 s8, s5, 1
  s_add_u32 s70, s70, s8
  s_mov_b32 s50, 16777216
  s_mov_b32 s51, 0x20000
  s_mov_b32 s54, 1835008
  s_mov_b32 s55, 0x20000
  s_mov_b32 s58, 1605632
  s_mov_b32 s59, 0x20000
  s_mov_b32 s62, 1835008
  s_mov_b32 s63, 0x20000
  s_mov_b32 s14, 0xffff0000
  s_mov_b32 s11, 14680064
  v_lshlrev_b32 v3, 4, v1
  s_cmp_ge_u32 s5, 28
  s_cbranch_scc1 L_spare
  s_cmp_ge_u32 s74, 4
  s_cbranch_scc1 L_S
  s_setprio 1
  s_mov_b32 s62, 1605632
  s_mov_b64 s[72:73], s[12:13]
  v_lshrrev_b32 v4, 4, v1
  v_and_b32 v2, 15, v1
  v_lshlrev_b32 v10, 2, v4
  v_xor_b32_e64 v2, v2, v10
  v_mul_u32_u24 v4, 3584, v4
  v_lshl_add_u32 v24, v2, 4, v4
  v_add_u32 v25, 13312, v24
  v_add_u32 v26, 26624, v24
  v_add_u32 v27, 39936, v24
  s_lshl_b32 s12, s71, 3
  s_add_u32 s12, s12, s3
  s_lshl_b32 s13, s68, 8
  s_lshl_b32 s15, s3, 12
  s_add_u32 s15, s15, 49152
  s_waitcnt lgkmcnt(0)
  s_mov_b32 s52, s16
  s_mov_b32 s53, s17
  s_mov_b32 s60, s40
  s_mov_b32 s61, s41
  s_mov_b32 s56, s36
  s_mov_b32 s57, s37
  buffer_load_dword v12, v14, s[48:51], s11 offen sc1
  s_barrier
  s_lshl_b32 s20, s70, 1
  s_add_u32 s20, s20, s3
  s_mul_i32 s20, s20, 1792
  v_min_u32_e64 v2, 55, v1
  v_lshlrev_b32 v2, 5, v2
  buffer_load_dwordx2 a[124:125], v2, s[56:59], s20 offen
  s_mul_i32 s20, s12, 57344
  s_add_u32 m0, s15, 0
  s_add_u32 s20, s20, s13
  s_add_u32 s12, s12, 4
  buffer_load_dwordx4 v24, s[56:59], s20 offen offset:0 lds
  buffer_load_dwordx4 v25, s[56:59], s20 offen offset:1024 lds
  buffer_load_dwordx4 v26, s[56:59], s20 offen offset:2048 lds
  buffer_load_dwordx4 v27, s[56:59], s20 offen offset:3072 lds
  s_sub_u32 s10, s12, 28
  s_cselect_b32 s12, s12, s10
  s_mul_i32 s20, s12, 57344
  s_add_u32 m0, s15, 16384
  s_add_u32 s20, s20, s13
  s_add_u32 s12, s12, 4
  buffer_load_dwordx4 v24, s[56:59], s20 offen offset:0 lds
  buffer_load_dwordx4 v25, s[56:59], s20 offen offset:1024 lds
  buffer_load_dwordx4 v26, s[56:59], s20 offen offset:2048 lds
  buffer_load_dwordx4 v27, s[56:59], s20 offen offset:3072 lds
  s_sub_u32 s10, s12, 28
  s_cselect_b32 s12, s12, s10
  s_branch L_G_setup
L_S:
  s_lshl_b32 s8, s70, 9
  v_and_b32 v4, 0xff, v0
  v_lshl_add_u32 v4, v4, 2, s8
  s_lshl_b32 s9, s70, 1
  s_waitcnt lgkmcnt(0)
  s_mov_b32 s52, s16
  s_mov_b32 s53, s17
  s_mov_b32 s60, s44
  s_mov_b32 s61, s45
  s_mov_b32 s56, s36
  s_mov_b32 s57, s37
  global_load_dword v120, v4, s[18:19]
  global_load_dword v121, v4, s[20:21]
  global_load_dword v122, v4, s[22:23]
  global_load_dword v123, v4, s[24:25]
  global_load_dword v124, v4, s[26:27]
  global_load_dword v125, v4, s[28:29]
  v_mov_b32_e64 v100, v4
  s_load_dword s71, s[30:31], s9
  s_load_dword s72, s[32:33], s9
  v_and_b32 v10, 7, v1
  v_lshlrev_b32 v10, 21, v10
  buffer_load_dword a100, v10, s[48:51], 0 offen
  buffer_load_dword a101, v14, s[60:63], 0 offen
  s_barrier
  s_branch L_S_body
L_spare:
  s_lshl_b32 s9, s4, 2
  s_add_u32 s9, s9, s5
  s_sub_u32 s9, s9, 28
  s_lshl_b32 s8, s9, 3
  s_add_u32 s8, s8, s74
  s_mul_i32 s75, s8, 7168
  v_and_b32 v6, 7, v1
  v_lshrrev_b32 v5, 3, v1
  v_mul_u32_u24 v7, 896, v5
  v_lshl_add_u32 v7, v6, 4, v7
  s_waitcnt lgkmcnt(0)
  s_mov_b32 s52, s16
  s_mov_b32 s53, s17
  s_mov_b32 s60, s44
  s_mov_b32 s61, s45
  s_mov_b32 s56, s36
  s_mov_b32 s57, s37
  buffer_load_dword v12, v14, s[48:51], s11 offen sc1
  buffer_load_dwordx4 v[16:19], v7, s[52:55], s75 offen offset:0
  buffer_load_dwordx4 v[20:23], v7, s[52:55], s75 offen offset:128
  buffer_load_dwordx4 v[24:27], v7, s[52:55], s75 offen offset:256
  buffer_load_dwordx4 v[28:31], v7, s[52:55], s75 offen offset:384
  buffer_load_dwordx4 v[32:35], v7, s[52:55], s75 offen offset:512
  buffer_load_dwordx4 v[36:39], v7, s[52:55], s75 offen offset:640
  buffer_load_dwordx4 v[40:43], v7, s[52:55], s75 offen offset:768
  s_branch L_sp_body
.p2align 6
L_G_setup:
  s_lshl_b32 s10, s3, 6
  s_add_u32 s10, s10, s13
  v_and_b32_e64 v28, 31, v1
  v_lshl_add_u32 v2, v28, 1, s10
  global_load_ushort v65, v2, s[38:39]
  v_lshrrev_b32_e64 v29, 5, v1
  v_bfe_u32 v2, v1, 2, 2
  v_lshl_add_u32 v30, v29, 3, v2
  v_lshlrev_b32 v30, 8, v30
  s_waitcnt vmcnt(11)
  v_xor_b32_e64 v11, s3, v2
  v_lshl_add_u32 v30, v11, 6, v30
  v_bfe_u32 v11, v1, 4, 1
  v_lshlrev_b32 v11, 5, v11
  v_and_b32 v13, 3, v1
  v_lshl_add_u32 v11, v13, 3, v11
  v_add_u32_e64 v30, v30, v11
  v_add_u32 v30, 49152, v30
  v_add_u32 v31, 0x10000, v30
  v_lshl_add_u32 v80, v29, 2, v2
  v_lshl_add_u32 v80, v80, 7, v11
  v_lshrrev_b32_e64 v2, 1, v2
  v_lshl_add_u32 v80, v2, 6, v80
  s_mul_i32 s21, s3, 7168
  s_add_u32 s21, s21, 49152
  v_add_u32 v80, s21, v80
  v_xor_b32 v81, 64, v80
  v_add_u32 v82, 57344, v80
  v_add_u32 v83, 57344, v81
  v_lshrrev_b32 v2, 3, v1
  v_and_b32 v11, 7, v1
  v_bfe_u32 v13, v1, 4, 1
  v_lshlrev_b32 v13, 2, v13
  v_xor_b32 v13, v13, v11
  v_mul_u32_u24 v5, 896, v2
  v_xor_b32 v11, v11, v2
  s_and_b32 s10, s3, 1
  v_xor_b32_e64 v11, s10, v11
  v_lshl_add_u32 v4, v11, 4, v5
  v_lshl_add_u32 v5, v13, 4, v5
  v_and_b32 v2, 7, v28
  v_lshrrev_b32 v11, 3, v28
  v_lshlrev_b32 v7, 7, v28
  v_and_b32 v11, 1, v11
  v_xor_b32 v2, v2, v11
  v_xor_b32 v2, v2, v29
  v_lshl_add_u32 v7, v2, 4, v7
  v_xor_b32 v8, 32, v7
  v_xor_b32 v9, 64, v7
  v_xor_b32 v10, 96, v7
  v_lshlrev_b32 v13, 3, v1
  s_lshl_b32 s28, s67, 10
  s_add_u32 s28, s28, 14876672
  s_lshl_b32 s8, s67, 4
  s_add_u32 s8, s8, s3
  s_mul_i32 s8, s8, 7168
  s_lshl_b32 s9, s71, 8
  s_add_u32 s29, s8, s9
  s_add_u32 s9, s9, 128
  s_cmp_eq_u32 s9, 896
  s_cselect_b32 s9, 0, s9
  s_add_u32 s30, s8, s9
  s_add_u32 s9, s9, 128
  s_cmp_eq_u32 s9, 896
  s_cselect_b32 s9, 0, s9
  s_add_u32 s31, s8, s9
  s_add_u32 s9, s9, 128
  s_cmp_eq_u32 s9, 896
  s_cselect_b32 s9, 0, s9
  s_add_u32 s32, s8, s9
  s_add_u32 s9, s9, 128
  s_cmp_eq_u32 s9, 896
  s_cselect_b32 s9, 0, s9
  s_add_u32 s33, s8, s9
  s_add_u32 s9, s9, 128
  s_cmp_eq_u32 s9, 896
  s_cselect_b32 s9, 0, s9
  s_add_u32 s34, s8, s9
  s_add_u32 s9, s9, 128
  s_cmp_eq_u32 s9, 896
  s_cselect_b32 s9, 0, s9
  s_add_u32 s35, s8, s9
  s_mul_i32 s26, s3, 401408
  s_lshl_b32 s9, s7, 7
  s_add_u32 s26, s26, s9
  s_lshr_b32 s9, s69, 1
  s_lshl_b32 s23, s9, 10
  s_add_u32 s23, s23, 14721024
  s_lshl_b32 s9, s9, 2
  s_and_b32 s10, s69, 1
  s_add_u32 s9, s9, s10
  s_mul_i32 s27, s9, 114688
  s_mul_i32 s9, s3, 28672
  s_add_u32 s27, s27, s9
  s_add_u32 s27, s27, 6291456
  s_mul_i32 s9, s6, 0
  s_mul_i32 s10, s7, 1
  s_add_u32 s9, s9, s10
  s_mul_i32 s10, s4, 1
  s_add_u32 s9, s9, s10
  s_and_b32 s9, s9, 3
  s_mul_i32 s10, s9, 100352
  s_add_u32 s40, s26, s10
  s_mul_i32 s10, s9, 7168
  s_add_u32 s44, s27, s10
  s_add_u32 s9, s9, 1
  s_and_b32 s9, s9, 3
  s_mul_i32 s10, s9, 100352
  s_add_u32 s41, s26, s10
  s_mul_i32 s10, s9, 7168
  s_add_u32 s45, s27, s10
  s_add_u32 s9, s9, 1
  s_and_b32 s9, s9, 3
  s_mul_i32 s10, s9, 100352
  s_add_u32 s42, s26, s10
  s_mul_i32 s10, s9, 7168
  s_add_u32 s46, s27, s10
  s_add_u32 s9, s9, 1
  s_and_b32 s9, s9, 3
  s_mul_i32 s10, s9, 100352
  s_add_u32 s43, s26, s10
  s_mul_i32 s10, s9, 7168
  s_add_u32 s47, s27, s10
  s_add_u32 s9, s9, 1
  s_mul_i32 s22, s67, 458752
  s_lshl_b32 s8, s68, 13
  s_add_u32 s22, s22, s8
  s_lshl_b32 s8, s3, 11
  s_add_u32 s22, s22, s8
  s_add_u32 s22, s22, 6291456
  s_lshl_b32 s25, s68, 2
  s_add_u32 s25, s25, s3
  s_mul_i32 s25, s25, 37
  s_lshr_b32 s25, s25, 9
  s_lshl_b32 s25, s25, 7
  s_lshl_b32 s8, s67, 10
  s_add_u32 s25, s25, s8
  s_add_u32 s25, s25, 14721024
  s_lshl_b32 s8, s3, 7
  s_add_u32 s23, s23, s8
  s_lshl_b32 s19, s3, 10
  s_lshl_b32 s36, s3, 2
  s_add_u32 s36, s36, 28672
  v_lshrrev_b32 v2, 2, v1
  v_lshrrev_b32 v11, 4, v1
  v_xor_b32 v2, v2, v11
  v_and_b32 v2, 1, v2
  v_cmp_eq_u32_e64 vcc, 0, v2
  v_mov_b32 v2, 0x3f803f80
  s_lshl_b32 s24, s70, 1
  s_add_u32 s24, s24, s3
  v_cndmask_b32 v68, 0, v2, vcc
  v_cndmask_b32 v69, 0, v2, vcc
  v_cndmask_b32 v70, 0, v2, vcc
  v_cndmask_b32 v71, 0, v2, vcc
  s_mul_i32 s24, s24, 1792
  v_mov_b32 v66, 0
  v_mov_b32 v67, 0
  v_min_u32_e64 v23, 13, v1
  v_lshlrev_b32 v23, 7, v23
  s_add_u32 m0, s19, 0
  s_nop 0
  buffer_load_dwordx4 v4, s[52:55], s29 offen lds
  s_add_u32 m0, s19, 4096
  s_nop 0
  buffer_load_dwordx4 v4, s[52:55], s30 offen lds
  s_mul_i32 s20, s12, 57344
  s_add_u32 m0, s15, 32768
  s_add_u32 s20, s20, s13
  s_add_u32 s12, s12, 4
  buffer_load_dwordx4 v24, s[56:59], s20 offen offset:0 lds
  buffer_load_dwordx4 v25, s[56:59], s20 offen offset:1024 lds
  buffer_load_dwordx4 v26, s[56:59], s20 offen offset:2048 lds
  buffer_load_dwordx4 v27, s[56:59], s20 offen offset:3072 lds
  s_sub_u32 s10, s12, 28
  s_cselect_b32 s12, s12, s10
  s_add_u32 m0, s19, 8192
  s_nop 0
  buffer_load_dwordx4 v4, s[52:55], s31 offen lds
  s_add_u32 m0, s36, 32
  s_mov_b64 exec, 1
  global_load_lds_dword v14, s[72:73]
  s_mov_b64 exec, -1
  s_mul_i32 s20, s12, 57344
  s_add_u32 m0, s15, 49152
  s_add_u32 s20, s20, s13
  s_add_u32 s12, s12, 4
  buffer_load_dwordx4 v24, s[56:59], s20 offen offset:0 lds
  buffer_load_dwordx4 v25, s[56:59], s20 offen offset:1024 lds
  buffer_load_dwordx4 v26, s[56:59], s20 offen offset:2048 lds
  buffer_load_dwordx4 v27, s[56:59], s20 offen offset:3072 lds
  s_sub_u32 s10, s12, 28
  s_cselect_b32 s12, s12, s10
  s_add_u32 m0, s19, 12288
  s_nop 0
  s_nop 0
  buffer_load_dwordx4 v4, s[52:55], s32 offen lds
  s_waitcnt vmcnt(23)
  v_add_u32 v12, 0x9e3779b9, v12
  s_nop 0
  v_readfirstlane_b32 s64, v12
  v_readfirstlane_b32 s65, v12
  ds_write_b32 v14, v12 offset:49084
  s_mov_b64 exec, 1
  ds_add_u32 v14, v15 offset:49064
  s_mov_b64 exec, -1
  s_mul_i32 s20, s12, 57344
  s_add_u32 m0, s15, 65536
  s_add_u32 s20, s20, s13
  s_add_u32 s12, s12, 4
  buffer_load_dwordx4 v24, s[56:59], s20 offen offset:0 lds
  buffer_load_dwordx4 v25, s[56:59], s20 offen offset:1024 lds
  buffer_load_dwordx4 v26, s[56:59], s20 offen offset:2048 lds
  buffer_load_dwordx4 v27, s[56:59], s20 offen offset:3072 lds
  s_sub_u32 s10, s12, 28
  s_cselect_b32 s12, s12, s10
  s_add_u32 m0, s19, 16384
  s_nop 0
  buffer_load_dwordx4 v4, s[52:55], s33 offen lds
  s_add_u32 m0, s36, 64
  s_mov_b64 exec, 1
  global_load_lds_dword v14, s[72:73]
  s_mov_b64 exec, -1
  s_setprio 2
  s_waitcnt vmcnt(11)
  ds_read_b128 v[124:127], v14 offset:28704
  s_waitcnt lgkmcnt(0)
  v_min_u32 v124, v124, v125
  v_min3_u32 v124, v124, v126, v127
  v_cmp_eq_u32_e64 vcc, 0, v124
  s_nop 0
  s_cbranch_vccz DOK_1
  s_mov_b32 s66, 0x2000000
DLP_2:
  ds_read_b128 v[124:127], v14 offset:28704
  s_waitcnt lgkmcnt(0)
  v_min_u32 v124, v124, v125
  v_min3_u32 v124, v124, v126, v127
  v_cmp_eq_u32 vcc, 0, v124
  s_sub_u32 s66, s66, 1
  s_cbranch_scc1 DOK_1
  s_cbranch_vccnz DLP_2
DOK_1:
  ds_read_b64_tr_b16 a[0:1], v30 offset:0
  ds_read_b64_tr_b16 a[2:3], v30 offset:1024
  ds_read_b64_tr_b16 a[4:5], v30 offset:4096
  ds_read_b64_tr_b16 a[6:7], v30 offset:5120
  ds_read_b64_tr_b16 a[8:9], v30 offset:8192
  ds_read_b64_tr_b16 a[10:11], v30 offset:9216
  ds_read_b128 v[48:51], v7 offset:0
  ds_read_b128 v[52:55], v8 offset:0
  ds_read_b128 v[56:59], v9 offset:0
  s_waitcnt lgkmcnt(2)
  s_nop 0
  v_mfma_f32_32x32x16_bf16 v[32:47], a[0:3], v[48:51], 0
  ds_read_b64_tr_b16 a[12:13], v30 offset:12288
  ds_read_b64_tr_b16 a[14:15], v30 offset:13312
  ds_read_b64_tr_b16 a[16:17], v30 offset:16384
  ds_read_b64_tr_b16 a[18:19], v30 offset:17408
  v_mfma_f32_16x16x32_bf16 v[96:99], v[68:71], a[0:3], 0
  ds_read_b128 v[60:63], v10 offset:0
  s_mul_i32 s20, s12, 57344
  s_add_u32 m0, s15, 81920
  s_add_u32 s20, s20, s13
  s_add_u32 s12, s12, 4
  buffer_load_dwordx4 v24, s[56:59], s20 offen offset:0 lds
  buffer_load_dwordx4 v25, s[56:59], s20 offen offset:1024 lds
  s_waitcnt lgkmcnt(6)
  s_nop 0
  v_mfma_f32_32x32x16_bf16 v[32:47], a[4:7], v[52:55], v[32:47]
  ds_read_b64_tr_b16 a[20:21], v30 offset:20480
  ds_read_b64_tr_b16 a[22:23], v30 offset:21504
  ds_read_b64_tr_b16 a[24:25], v30 offset:24576
  ds_read_b64_tr_b16 a[26:27], v30 offset:25600
  v_mfma_f32_16x16x32_bf16 v[96:99], v[68:71], a[4:7], v[96:99]
  ds_read_b128 v[76:79], v7 offset:4096
  buffer_load_dwordx4 v26, s[56:59], s20 offen offset:2048 lds
  buffer_load_dwordx4 v27, s[56:59], s20 offen offset:3072 lds
  s_sub_u32 s10, s12, 28
  s_cselect_b32 s12, s12, s10
  s_waitcnt lgkmcnt(10)
  s_nop 0
  v_mfma_f32_32x32x16_bf16 v[32:47], a[8:11], v[56:59], v[32:47]
  ds_read_b64_tr_b16 a[28:29], v30 offset:28672
  ds_read_b64_tr_b16 a[30:31], v30 offset:29696
  s_mov_b64 exec, 1
  ds_add_u32 v14, v15 offset:49060
  s_mov_b64 exec, -1
  ds_read_b64_tr_b16 a[32:33], v30 offset:32768
  ds_read_b64_tr_b16 a[34:35], v30 offset:33792
  v_mfma_f32_16x16x32_bf16 v[96:99], v[68:71], a[8:11], v[96:99]
  ds_read_b128 v[112:115], v8 offset:4096
  s_add_u32 m0, s19, 20480
  s_nop 0
  buffer_load_dwordx4 v4, s[52:55], s34 offen lds
  s_add_u32 m0, s36, 80
  s_mov_b64 exec, 1
  global_load_lds_dword v14, s[72:73]
  s_mov_b64 exec, -1
  s_mul_i32 s20, s12, 57344
  s_add_u32 m0, s15, 98304
  s_add_u32 s20, s20, s13
  s_add_u32 s12, s12, 4
  buffer_load_dwordx4 v24, s[56:59], s20 offen offset:0 lds
  s_waitcnt lgkmcnt(11)
  v_mfma_f32_32x32x16_bf16 v[32:47], a[12:15], v[60:63], v[32:47]
  ds_read_b64_tr_b16 a[36:37], v30 offset:36864
  ds_read_b64_tr_b16 a[38:39], v30 offset:37888
  ds_read_b64_tr_b16 a[40:41], v30 offset:40960
  ds_read_b64_tr_b16 a[42:43], v30 offset:41984
  v_mfma_f32_16x16x32_bf16 v[96:99], v[68:71], a[12:15], v[96:99]
  ds_read_b128 v[116:119], v9 offset:4096
  buffer_load_dwordx4 v25, s[56:59], s20 offen offset:1024 lds
  buffer_load_dwordx4 v26, s[56:59], s20 offen offset:2048 lds
  s_waitcnt lgkmcnt(11)
  v_mfma_f32_32x32x16_bf16 v[32:47], a[16:19], v[76:79], v[32:47]
  ds_read_b64_tr_b16 a[44:45], v30 offset:45056
  ds_read_b64_tr_b16 a[46:47], v30 offset:46080
  s_waitcnt vmcnt(9)
  ds_read_b128 v[124:127], v14 offset:28736
  s_waitcnt lgkmcnt(0)
  v_min_u32 v124, v124, v125
  v_min3_u32 v124, v124, v126, v127
  v_cmp_eq_u32_e64 vcc, 0, v124
  s_nop 0
  s_cbranch_vccz DOK_4
  s_mov_b32 s66, 0x2000000
DLP_5:
  ds_read_b128 v[124:127], v14 offset:28736
  s_waitcnt lgkmcnt(0)
  v_min_u32 v124, v124, v125
  v_min3_u32 v124, v124, v126, v127
  v_cmp_eq_u32 vcc, 0, v124
  s_sub_u32 s66, s66, 1
  s_cbranch_scc1 DOK_4
  s_cbranch_vccnz DLP_5
DOK_4:
  ds_read_b64_tr_b16 a[48:49], v30 offset:49152
  ds_read_b64_tr_b16 a[50:51], v30 offset:50176
  v_mfma_f32_16x16x32_bf16 v[96:99], v[68:71], a[16:19], v[96:99]
  ds_read_b128 v[48:51], v10 offset:4096
  buffer_load_dwordx4 v27, s[56:59], s20 offen offset:3072 lds
  s_sub_u32 s10, s12, 28
  s_cselect_b32 s12, s12, s10
  s_add_u32 m0, s19, 24576
  s_nop 0
  s_nop 0
  buffer_load_dwordx4 v4, s[52:55], s35 offen lds
  v_add_u32 v4, 28672, v4
  s_add_u32 m0, s36, 96
  s_mov_b64 exec, 1
  global_load_lds_dword v14, s[72:73]
  s_mov_b64 exec, -1
  v_mfma_f32_32x32x16_bf16 v[32:47], a[20:23], v[112:115], v[32:47]
  ds_read_b64_tr_b16 a[52:53], v30 offset:53248
  ds_read_b64_tr_b16 a[54:55], v30 offset:54272
  ds_read_b64_tr_b16 a[56:57], v30 offset:57344
  ds_read_b64_tr_b16 a[58:59], v30 offset:58368
  v_mfma_f32_16x16x32_bf16 v[96:99], v[68:71], a[20:23], v[96:99]
  ds_read_b128 v[52:55], v7 offset:8192
  ds_read_b32 v6, v14 offset:49060
  v_mfma_f32_32x32x16_bf16 v[32:47], a[24:27], v[116:119], v[32:47]
  ds_read_b64_tr_b16 a[60:61], v30 offset:61440
  ds_read_b64_tr_b16 a[62:63], v30 offset:62464
  ds_read_b64_tr_b16 a[64:65], v31 offset:0
  ds_read_b64_tr_b16 a[66:67], v31 offset:1024
  v_mfma_f32_16x16x32_bf16 v[96:99], v[68:71], a[24:27], v[96:99]
  ds_read_b128 v[56:59], v8 offset:8192
  s_waitcnt lgkmcnt(11)
  s_nop 0
  v_mfma_f32_32x32x16_bf16 v[32:47], a[28:31], v[48:51], v[32:47]
  ds_read_b64_tr_b16 a[68:69], v31 offset:4096
  ds_read_b64_tr_b16 a[70:71], v31 offset:5120
  ds_read_b64_tr_b16 a[72:73], v31 offset:8192
  ds_read_b64_tr_b16 a[74:75], v31 offset:9216
  v_mfma_f32_16x16x32_bf16 v[96:99], v[68:71], a[28:31], v[96:99]
  ds_read_b128 v[60:63], v9 offset:8192
  s_waitcnt lgkmcnt(10)
  v_cmp_gt_u32 vcc, 4, v6
  s_nop 0
  s_cbranch_vccz COK_7
  s_mov_b32 s66, 0x2000000
CLP_8:
  ds_read_b32 v6, v14 offset:49060
  s_waitcnt lgkmcnt(0)
  v_cmp_gt_u32 vcc, 4, v6
  s_sub_u32 s66, s66, 1
  s_cbranch_scc1 COK_7
  s_cbranch_vccnz CLP_8
COK_7:
  s_add_u32 m0, s19, 49152
  s_nop 0
  buffer_load_dwordx4 v4, s[52:55], s29 offen lds
  v_mfma_f32_32x32x16_bf16 v[32:47], a[32:35], v[52:55], v[32:47]
  ds_read_b64_tr_b16 a[76:77], v31 offset:12288
  ds_read_b64_tr_b16 a[78:79], v31 offset:13312
  s_waitcnt vmcnt(7)
  ds_read_b128 v[124:127], v14 offset:28752
  s_waitcnt lgkmcnt(0)
  v_min_u32_e64 v124, v124, v125
  v_min3_u32 v124, v124, v126, v127
  v_cmp_eq_u32_e64 vcc, 0, v124
  s_nop 0
  s_cbranch_vccz DOK_10
  s_mov_b32 s66, 0x2000000
DLP_11:
  ds_read_b128 v[124:127], v14 offset:28752
  s_waitcnt lgkmcnt(0)
  v_min_u32 v124, v124, v125
  v_min3_u32 v124, v124, v126, v127
  v_cmp_eq_u32 vcc, 0, v124
  s_sub_u32 s66, s66, 1
  s_cbranch_scc1 DOK_10
  s_cbranch_vccnz DLP_11
DOK_10:
  ds_read_b64_tr_b16 a[80:81], v31 offset:16384
  ds_read_b64_tr_b16 a[82:83], v31 offset:17408
  v_mfma_f32_16x16x32_bf16 v[96:99], v[68:71], a[32:35], v[96:99]
  ds_read_b128 v[76:79], v10 offset:8192
  s_add_u32 m0, s19, 53248
  s_nop 0
  s_nop 0
  buffer_load_dwordx4 v4, s[52:55], s30 offen lds
  v_mfma_f32_32x32x16_bf16 v[32:47], a[36:39], v[56:59], v[32:47]
  ds_read_b64_tr_b16 a[84:85], v31 offset:20480
  ds_read_b64_tr_b16 a[86:87], v31 offset:21504
  ds_read_b64_tr_b16 a[88:89], v31 offset:24576
  ds_read_b64_tr_b16 a[90:91], v31 offset:25600
  v_mfma_f32_16x16x32_bf16 v[96:99], v[68:71], a[36:39], v[96:99]
  ds_read_b128 v[112:115], v7 offset:12288
  s_add_u32 m0, s19, 57344
  s_nop 0
  buffer_load_dwordx4 v4, s[52:55], s31 offen lds
  v_mfma_f32_32x32x16_bf16 v[32:47], a[40:43], v[60:63], v[32:47]
  ds_read_b64_tr_b16 a[92:93], v31 offset:28672
  ds_read_b64_tr_b16 a[94:95], v31 offset:29696
  s_waitcnt vmcnt(3)
  ds_read_b128 v[124:127], v14 offset:28768
  s_waitcnt lgkmcnt(0)
  v_min_u32 v124, v124, v125
  v_min3_u32 v124, v124, v126, v127
  v_cmp_eq_u32_e64 vcc, 0, v124
  s_nop 0
  s_cbranch_vccz DOK_13
  s_mov_b32 s66, 0x2000000
DLP_14:
  ds_read_b128 v[124:127], v14 offset:28768
  s_waitcnt lgkmcnt(0)
  v_min_u32 v124, v124, v125
  v_min3_u32 v124, v124, v126, v127
  v_cmp_eq_u32 vcc, 0, v124
  s_sub_u32 s66, s66, 1
  s_cbranch_scc1 DOK_13
  s_cbranch_vccnz DLP_14
DOK_13:
  ds_read_b64_tr_b16 a[96:97], v31 offset:32768
  ds_read_b64_tr_b16 a[98:99], v31 offset:33792
  v_mfma_f32_16x16x32_bf16 v[96:99], v[68:71], a[40:43], v[96:99]
  ds_read_b128 v[116:119], v8 offset:12288
  s_add_u32 m0, s19, 61440
  s_nop 0
  s_nop 0
  buffer_load_dwordx4 v4, s[52:55], s32 offen lds
  v_mfma_f32_32x32x16_bf16 v[32:47], a[44:47], v[76:79], v[32:47]
  ds_read_b64_tr_b16 a[100:101], v31 offset:36864
  ds_read_b64_tr_b16 a[102:103], v31 offset:37888
  ds_read_b64_tr_b16 a[104:105], v31 offset:40960
  ds_read_b64_tr_b16 a[106:107], v31 offset:41984
  v_mfma_f32_16x16x32_bf16 v[96:99], v[68:71], a[44:47], v[96:99]
  ds_read_b128 v[48:51], v9 offset:12288
  s_add_u32 m0, s19, 65536
  s_nop 0
  s_nop 0
  buffer_load_dwordx4 v4, s[52:55], s33 offen lds
  v_mfma_f32_32x32x16_bf16 v[32:47], a[48:51], v[112:115], v[32:47]
  ds_read_b64_tr_b16 a[108:109], v31 offset:45056
  ds_read_b64_tr_b16 a[110:111], v31 offset:46080
  s_mov_b64 exec, 1
  ds_add_u32 v14, v15 offset:49052
  s_mov_b64 exec, -1
  v_mfma_f32_16x16x32_bf16 v[96:99], v[68:71], a[48:51], v[96:99]
  ds_read_b128 v[52:55], v10 offset:12288
  s_add_u32 m0, s19, 69632
  s_nop 0
  buffer_load_dwordx4 v4, s[52:55], s34 offen lds
  s_waitcnt lgkmcnt(9)
  v_mfma_f32_32x32x16_bf16 v[32:47], a[52:55], v[116:119], v[32:47]
  v_mfma_f32_16x16x32_bf16 v[96:99], v[68:71], a[52:55], v[96:99]
  ds_read_b128 v[56:59], v7 offset:16384
  s_add_u32 m0, s19, 73728
  s_nop 0
  buffer_load_dwordx4 v4, s[52:55], s35 offen lds
  v_add_u32 v4, 28672, v4
  s_add_u32 m0, s36, 112
  s_mov_b64 exec, 1
  global_load_lds_dword v14, s[72:73]
  s_mov_b64 exec, -1
  s_waitcnt lgkmcnt(5)
  v_mfma_f32_32x32x16_bf16 v[32:47], a[56:59], v[48:51], v[32:47]
  v_mfma_f32_16x16x32_bf16 v[96:99], v[68:71], a[56:59], v[96:99]
  ds_read_b128 v[60:63], v8 offset:16384
  ds_read_b32 v6, v14 offset:49052
  s_waitcnt lgkmcnt(3)
  v_mfma_f32_32x32x16_bf16 v[32:47], a[60:63], v[52:55], v[32:47]
  v_mfma_f32_16x16x32_bf16 v[96:99], v[68:71], a[60:63], v[96:99]
  ds_read_b128 v[76:79], v9 offset:16384
  s_waitcnt lgkmcnt(3)
  v_mfma_f32_32x32x16_bf16 v[32:47], a[64:67], v[56:59], v[32:47]
  v_mfma_f32_16x16x32_bf16 v[96:99], v[68:71], a[64:67], v[96:99]
  ds_read_b128 v[112:115], v10 offset:16384
  s_waitcnt lgkmcnt(2)
  v_cmp_gt_u32 vcc, 4, v6
  s_nop 0
  s_cbranch_vccz COK_16
  s_mov_b32 s66, 0x2000000
CLP_17:
  ds_read_b32 v6, v14 offset:49052
  s_waitcnt lgkmcnt(0)
  v_cmp_gt_u32 vcc, 4, v6
  s_sub_u32 s66, s66, 1
  s_cbranch_scc1 COK_16
  s_cbranch_vccnz CLP_17
COK_16:
  s_add_u32 m0, s19, 77824
  s_nop 0
  buffer_load_dwordx4 v4, s[52:55], s29 offen lds
  v_mfma_f32_32x32x16_bf16 v[32:47], a[68:71], v[60:63], v[32:47]
  v_mfma_f32_16x16x32_bf16 v[96:99], v[68:71], a[68:71], v[96:99]
  ds_read_b128 v[116:119], v7 offset:20480
  s_add_u32 m0, s19, 81920
  s_nop 0
  buffer_load_dwordx4 v4, s[52:55], s30 offen lds
  s_waitcnt lgkmcnt(2)
  v_mfma_f32_32x32x16_bf16 v[32:47], a[72:75], v[76:79], v[32:47]
  v_mfma_f32_16x16x32_bf16 v[96:99], v[68:71], a[72:75], v[96:99]
  ds_read_b128 v[48:51], v8 offset:20480
  s_add_u32 m0, s19, 86016
  s_nop 0
  buffer_load_dwordx4 v4, s[52:55], s31 offen lds
  s_waitcnt lgkmcnt(2)
  v_mfma_f32_32x32x16_bf16 v[32:47], a[76:79], v[112:115], v[32:47]
  v_mfma_f32_16x16x32_bf16 v[96:99], v[68:71], a[76:79], v[96:99]
  ds_read_b128 v[52:55], v9 offset:20480
  buffer_load_dwordx2 v[84:85], v13, s[48:51], s28 offen offset:0 sc1
  buffer_load_dwordx2 v[86:87], v13, s[48:51], s28 offen offset:512 sc1
  s_waitcnt lgkmcnt(2)
  s_nop 0
  v_mfma_f32_32x32x16_bf16 v[32:47], a[80:83], v[116:119], v[32:47]
  v_mfma_f32_16x16x32_bf16 v[96:99], v[68:71], a[80:83], v[96:99]
  ds_read_b128 v[56:59], v10 offset:20480
  s_add_u32 m0, s19, 90112
  s_nop 0
  buffer_load_dwordx4 v4, s[52:55], s32 offen lds
  s_waitcnt lgkmcnt(2)
  v_mfma_f32_32x32x16_bf16 v[32:47], a[84:87], v[48:51], v[32:47]
  v_mfma_f32_16x16x32_bf16 v[96:99], v[68:71], a[84:87], v[96:99]
  ds_read_b128 v[60:63], v7 offset:24576
  s_add_u32 m0, s19, 94208
  s_nop 0
  buffer_load_dwordx4 v4, s[52:55], s33 offen lds
  s_waitcnt lgkmcnt(2)
  v_mfma_f32_32x32x16_bf16 v[32:47], a[88:91], v[52:55], v[32:47]
  v_mfma_f32_16x16x32_bf16 v[96:99], v[68:71], a[88:91], v[96:99]
  ds_read_b128 v[76:79], v8 offset:24576
  s_add_u32 m0, s19, 98304
  s_nop 0
  buffer_load_dwordx4 v4, s[52:55], s34 offen lds
  s_waitcnt lgkmcnt(2)
  v_mfma_f32_32x32x16_bf16 v[32:47], a[92:95], v[56:59], v[32:47]
  v_mfma_f32_16x16x32_bf16 v[96:99], v[68:71], a[92:95], v[96:99]
  ds_read_b128 v[112:115], v9 offset:24576
  s_add_u32 m0, s19, 102400
  s_nop 0
  buffer_load_dwordx4 v4, s[52:55], s35 offen lds
  v_add_u32 v4, 28672, v4
  s_add_u32 m0, s36, 128
  s_mov_b64 exec, 1
  global_load_lds_dword v14, s[72:73]
  s_mov_b64 exec, -1
  s_waitcnt lgkmcnt(2)
  v_mfma_f32_32x32x16_bf16 v[32:47], a[96:99], v[60:63], v[32:47]
  v_mfma_f32_16x16x32_bf16 v[96:99], v[68:71], a[96:99], v[96:99]
  ds_read_b128 v[116:119], v10 offset:24576
  s_mov_b64 exec, 1
  s_nop 0
  ds_add_u32 v14, v15 offset:49040
  s_mov_b64 exec, -1
  s_add_u32 m0, s19, 106496
  s_nop 0
  buffer_load_dwordx4 v4, s[52:55], s29 offen lds
  ds_read_b128 v[124:127], v14 offset:28784
  s_waitcnt lgkmcnt(4)
  v_mfma_f32_32x32x16_bf16 v[32:47], a[100:103], v[76:79], v[32:47]
  v_mfma_f32_16x16x32_bf16 v[96:99], v[68:71], a[100:103], v[96:99]
  s_waitcnt lgkmcnt(3)
  v_mfma_f32_32x32x16_bf16 v[32:47], a[104:107], v[112:115], v[32:47]
  v_mfma_f32_16x16x32_bf16 v[96:99], v[68:71], a[104:107], v[96:99]
  s_add_u32 m0, s19, 110592
  s_nop 0
  buffer_load_dwordx4 v4, s[52:55], s30 offen lds
  s_waitcnt lgkmcnt(2)
  v_mfma_f32_32x32x16_bf16 v[32:47], a[108:111], v[116:119], v[32:47]
  v_mfma_f32_16x16x32_bf16 v[96:99], v[68:71], a[108:111], v[96:99]
  s_add_u32 m0, s19, 114688
  s_nop 0
  buffer_load_dwordx4 v4, s[52:55], s31 offen lds
  s_setprio 2
  s_waitcnt lgkmcnt(0)
  v_min_u32 v124, v124, v125
  v_min3_u32 v124, v124, v126, v127
  v_cmp_eq_u32_e64 vcc, 0, v124
  s_nop 0
  s_cbranch_vccz DOK_19
  s_mov_b32 s66, 0x2000000
DLP_20:
  ds_read_b128 v[124:127], v14 offset:28784
  s_waitcnt lgkmcnt(0)
  v_min_u32 v124, v124, v125
  v_min3_u32 v124, v124, v126, v127
  v_cmp_eq_u32 vcc, 0, v124
  s_sub_u32 s66, s66, 1
  s_cbranch_scc1 DOK_19
  s_cbranch_vccnz DLP_20
DOK_19:
  v_add_u32 v7, 49152, v7
  ds_read_b128 v[48:51], v7 offset:0
  v_add_u32 v8, 49152, v8
  ds_read_b128 v[52:55], v8 offset:0
  v_add_u32 v9, 49152, v9
  ds_read_b128 v[56:59], v9 offset:0
  v_add_u32 v10, 49152, v10
  ds_read_b128 v[60:63], v10 offset:0
  ds_read_b128 v[76:79], v7 offset:4096
  ds_read_b128 v[112:115], v8 offset:4096
  ds_read_b128 v[116:119], v9 offset:4096
  s_waitcnt lgkmcnt(6)
  v_mfma_f32_32x32x16_bf16 v[16:31], a[0:3], v[48:51], 0
  ds_read_b128 v[48:51], v10 offset:4096
  s_add_u32 m0, s19, 118784
  s_nop 0
  buffer_load_dwordx4 v4, s[52:55], s32 offen lds
  s_waitcnt lgkmcnt(6)
  v_mfma_f32_32x32x16_bf16 v[16:31], a[4:7], v[52:55], v[16:31]
  ds_read_b128 v[52:55], v7 offset:8192
  s_waitcnt lgkmcnt(4)
  v_mfma_f32_32x32x16_bf16 v[16:31], a[8:11], v[56:59], v[16:31]
  s_waitcnt vmcnt(10)
  v_xor_b32 v2, s64, v85
  s_waitcnt vmcnt(9)
  v_xor_b32 v11, s64, v87
  v_or_b32 v2, v2, v11
  v_cmp_ne_u32 vcc, 0, v2
  s_nop 0
  s_cbranch_vccz L_stok
  s_mov_b32 s66, 0x100000
L_stlp:
  buffer_load_dwordx2 v[84:85], v13, s[48:51], s28 offen offset:0 sc1
  buffer_load_dwordx2 v[86:87], v13, s[48:51], s28 offen offset:512 sc1
  s_waitcnt vmcnt(0)
  v_xor_b32 v2, s64, v85
  v_xor_b32 v11, s64, v87
  v_or_b32 v2, v2, v11
  v_cmp_ne_u32 vcc, 0, v2
  s_sub_u32 s66, s66, 1
  s_cbranch_scc1 L_stok
  s_cbranch_vccnz L_stlp
L_stok:
  v_mov_b32 v72, v84
  v_mov_b32 v73, v86
  v_cvt_pk_bf16_f32 v2, 0, v96
  v_sub_f32 v11, v96, v2
  v_lshrrev_b32 v2, 16, v2
  v_lshl_or_b32 v64, v65, 16, v2
  v_cvt_pk_bf16_f32 v65, v11, 0
  s_mov_b32 s38, -1
  s_mov_b32 s39, 0
  v_add_u32 v13, 6144, v5
  v_cndmask_b32 v68, 0, v72, s[38:39]
  v_cndmask_b32 v69, 0, v72, s[38:39]
  s_nop 1
  s_nop 0
  v_mfma_f32_32x32x16_bf16 v[32:47], v[64:67], v[68:71], v[32:47]
  v_cndmask_b32 v68, v72, 0, s[38:39]
  v_cndmask_b32 v69, v72, 0, s[38:39]
  ds_read_b128 v[56:59], v8 offset:8192
  s_add_u32 m0, s19, 122880
  s_nop 0
  buffer_load_dwordx4 v4, s[52:55], s33 offen lds
  v_mfma_f32_32x32x16_bf16 v[16:31], a[12:15], v[60:63], v[16:31]
  ds_read_b128 v[60:63], v9 offset:8192
  s_add_u32 m0, s19, 126976
  s_nop 0
  buffer_load_dwordx4 v4, s[52:55], s34 offen lds
  v_mfma_f32_32x32x16_bf16 v[16:31], a[16:19], v[76:79], v[16:31]
  v_mfma_f32_32x32x16_bf16 v[16:31], v[64:67], v[68:71], v[16:31]
  v_cndmask_b32 v68, 0, v73, s[38:39]
  v_cndmask_b32 v69, 0, v73, s[38:39]
  ds_read_b128 v[76:79], v10 offset:8192
  s_waitcnt lgkmcnt(4)
  v_mfma_f32_32x32x16_bf16 v[16:31], a[20:23], v[112:115], v[16:31]
  ds_read_b128 v[112:115], v7 offset:12288
  s_add_u32 m0, s19, 131072
  s_nop 0
  buffer_load_dwordx4 v4, s[52:55], s35 offen lds
  v_add_u32 v4, 28672, v4
  s_add_u32 m0, s36, 144
  s_mov_b64 exec, 1
  global_load_lds_dword v14, s[72:73]
  s_mov_b64 exec, -1
  v_mul_f32 v2, v32, |v32|
  v_mul_f32 v11, v33, |v33|
  v_mfma_f32_32x32x16_bf16 v[16:31], a[24:27], v[116:119], v[16:31]
  ds_read_b128 v[116:119], v8 offset:12288
  v_cvt_pk_bf16_f32 v32, v2, v11
  v_pk_max_i16 v32, v32, 0
  v_mfma_f32_32x32x16_bf16 v[16:31], a[28:31], v[48:51], v[16:31]
  ds_read_b128 v[48:51], v9 offset:12288
  s_add_u32 m0, s21, 86016
  s_add_u32 s20, s40, 0
  buffer_load_dwordx4 v5, s[60:63], s20 offen lds
  v_mul_f32 v2, v34, |v34|
  v_mul_f32 v11, v35, |v35|
  s_waitcnt lgkmcnt(4)
  v_mfma_f32_32x32x16_bf16 v[16:31], a[32:35], v[52:55], v[16:31]
  ds_read_b128 v[52:55], v10 offset:12288
  v_cvt_pk_bf16_f32 v33, v2, v11
  v_pk_max_i16 v33, v33, 0
  v_mfma_f32_32x32x16_bf16 v[16:31], a[36:39], v[56:59], v[16:31]
  ds_read_b128 v[56:59], v7 offset:16384
  buffer_load_dwordx4 v13, s[60:63], s20 offen offset:1024 lds
  v_mul_f32 v2, v36, |v36|
  v_mul_f32 v11, v37, |v37|
  v_mfma_f32_32x32x16_bf16 v[16:31], a[40:43], v[60:63], v[16:31]
  ds_read_b128 v[60:63], v8 offset:16384
  s_add_u32 m0, s21, 88064
  s_add_u32 s20, s40, 14336
  buffer_load_dwordx4 v5, s[60:63], s20 offen lds
  v_cvt_pk_bf16_f32 v34, v2, v11
  v_pk_max_i16 v34, v34, 0
  s_waitcnt lgkmcnt(4)
  s_nop 0
  v_mfma_f32_32x32x16_bf16 v[16:31], a[44:47], v[76:79], v[16:31]
  ds_read_b128 v[76:79], v9 offset:16384
  v_mul_f32 v2, v38, |v38|
  v_mul_f32 v11, v39, |v39|
  v_mfma_f32_32x32x16_bf16 v[16:31], a[48:51], v[112:115], v[16:31]
  ds_read_b128 v[112:115], v10 offset:16384
  buffer_load_dwordx4 v13, s[60:63], s20 offen offset:1024 lds
  v_cvt_pk_bf16_f32 v35, v2, v11
  v_pk_max_i16 v35, v35, 0
  v_mfma_f32_32x32x16_bf16 v[16:31], a[52:55], v[116:119], v[16:31]
  ds_read_b128 v[116:119], v7 offset:20480
  buffer_store_dwordx4 v[32:35], v3, s[48:51], s22 offen offset:0 sc1
  v_mul_f32 v2, v40, |v40|
  s_waitcnt lgkmcnt(4)
  s_nop 0
  v_mfma_f32_32x32x16_bf16 v[16:31], a[56:59], v[48:51], v[16:31]
  ds_read_b128 v[48:51], v8 offset:20480
  v_mul_f32 v11, v41, |v41|
  v_cvt_pk_bf16_f32 v40, v2, v11
  v_mfma_f32_32x32x16_bf16 v[16:31], a[60:63], v[52:55], v[16:31]
  ds_read_b128 v[52:55], v9 offset:20480
  v_pk_max_i16 v40, v40, 0
  v_mul_f32 v2, v42, |v42|
  v_mfma_f32_32x32x16_bf16 v[16:31], a[64:67], v[56:59], v[16:31]
  ds_read_b128 v[56:59], v10 offset:20480
  s_add_u32 m0, s21, 90112
  s_add_u32 s20, s40, 28672
  buffer_load_dwordx4 v5, s[60:63], s20 offen lds
  v_mul_f32 v11, v43, |v43|
  v_cvt_pk_bf16_f32 v41, v2, v11
  s_waitcnt lgkmcnt(4)
  s_nop 0
  v_mfma_f32_32x32x16_bf16 v[16:31], a[68:71], v[60:63], v[16:31]
  ds_read_b128 v[60:63], v7 offset:24576
  v_pk_max_i16 v41, v41, 0
  v_mul_f32 v2, v44, |v44|
  v_mfma_f32_32x32x16_bf16 v[16:31], a[72:75], v[76:79], v[16:31]
  ds_read_b128 v[124:127], v14 offset:28800
  ds_read_b128 v[76:79], v8 offset:24576
  buffer_load_dwordx4 v13, s[60:63], s20 offen offset:1024 lds
  v_mul_f32 v11, v45, |v45|
  v_cvt_pk_bf16_f32 v42, v2, v11
  v_mfma_f32_32x32x16_bf16 v[16:31], a[76:79], v[112:115], v[16:31]
  ds_read_b128 v[112:115], v9 offset:24576
  s_add_u32 m0, s21, 92160
  s_add_u32 s20, s40, 43008
  buffer_load_dwordx4 v5, s[60:63], s20 offen lds
  v_pk_max_i16 v42, v42, 0
  v_mul_f32 v2, v46, |v46|
  s_waitcnt lgkmcnt(5)
  s_nop 0
  v_mfma_f32_32x32x16_bf16 v[16:31], a[80:83], v[116:119], v[16:31]
  ds_read_b128 v[116:119], v10 offset:24576
  s_mov_b64 exec, 1
  ds_add_u32 v14, v15 offset:49080
  s_mov_b64 exec, -1
  v_mul_f32 v11, v47, |v47|
  v_cvt_pk_bf16_f32 v43, v2, v11
  v_mfma_f32_32x32x16_bf16 v[16:31], a[84:87], v[48:51], v[16:31]
  s_waitcnt lgkmcnt(4)
  v_min_u32 v124, v124, v125
  v_min3_u32 v124, v124, v126, v127
  v_cmp_eq_u32_e64 vcc, 0, v124
  s_nop 0
  s_cbranch_vccnz DSL_24
DOK_22:
  v_add_u32 v7, 28672, v7
  ds_read_b128 v[48:51], v7 offset:0
  v_pk_max_i16 v43, v43, 0
  buffer_store_dwordx4 v[40:43], v3, s[48:51], s22 offen offset:1024 sc1
  v_mfma_f32_32x32x16_bf16 v[16:31], a[88:91], v[52:55], v[16:31]
  v_add_u32 v8, 28672, v8
  ds_read_b128 v[52:55], v8 offset:0
  s_add_u32 s22, s22, 114688
  s_waitcnt lgkmcnt(5)
  v_mfma_f32_32x32x16_bf16 v[16:31], a[92:95], v[56:59], v[16:31]
  v_add_u32 v9, 28672, v9
  ds_read_b128 v[56:59], v9 offset:0
  v_mfma_f32_32x32x16_bf16 v[16:31], a[96:99], v[60:63], v[16:31]
  v_add_u32 v10, 28672, v10
  ds_read_b128 v[60:63], v10 offset:0
  v_mfma_f32_32x32x16_bf16 v[16:31], a[100:103], v[76:79], v[16:31]
  ds_read_b128 v[76:79], v7 offset:4096
  s_waitcnt lgkmcnt(4)
  v_mfma_f32_32x32x16_bf16 v[16:31], a[104:107], v[112:115], v[16:31]
  ds_read_b128 v[112:115], v8 offset:4096
  v_mfma_f32_32x32x16_bf16 v[16:31], a[108:111], v[116:119], v[16:31]
  ds_read_b128 v[116:119], v9 offset:4096
  ds_read_b32 v6, v14 offset:49080
  v_mfma_f32_32x32x16_bf16 v[32:47], a[0:3], v[48:51], 0
  ds_read_b128 v[48:51], v10 offset:4096
  v_mfma_f32_32x32x16_bf16 v[32:47], v[64:67], v[68:71], v[32:47]
  v_cndmask_b32 v68, v73, 0, s[38:39]
  v_cndmask_b32 v69, v73, 0, s[38:39]
  s_waitcnt lgkmcnt(5)
  v_mfma_f32_32x32x16_bf16 v[32:47], a[4:7], v[52:55], v[32:47]
  ds_read_b128 v[52:55], v7 offset:8192
  v_mfma_f32_32x32x16_bf16 v[32:47], a[8:11], v[56:59], v[32:47]
  s_waitcnt lgkmcnt(2)
  v_cmp_gt_u32_e64 vcc, 4, v6
  s_nop 0
  s_cbranch_vccnz CSL_27
COK_25:
  ds_read_b128 v[56:59], v8 offset:8192
  v_mul_f32 v2, v16, |v16|
  v_mul_f32 v11, v17, |v17|
  v_mfma_f32_32x32x16_bf16 v[32:47], a[12:15], v[60:63], v[32:47]
  ds_read_b128 v[60:63], v9 offset:8192
  s_add_u32 m0, s21, 0
  s_nop 0
  s_add_u32 s20, s40, 50176
  buffer_load_dwordx4 v5, s[60:63], s20 offen lds
  v_cvt_pk_bf16_f32 v16, v2, v11
  v_pk_max_i16 v16, v16, 0
  v_mfma_f32_32x32x16_bf16 v[32:47], a[16:19], v[76:79], v[32:47]
  ds_read_b128 v[76:79], v10 offset:8192
  buffer_load_dwordx4 v13, s[60:63], s20 offen offset:1024 lds
  v_mul_f32 v2, v18, |v18|
  v_mul_f32 v11, v19, |v19|
  v_mfma_f32_32x32x16_bf16 v[32:47], a[20:23], v[112:115], v[32:47]
  ds_read_b128 v[112:115], v7 offset:12288
  v_cvt_pk_bf16_f32 v17, v2, v11
  v_pk_max_i16 v17, v17, 0
  v_mfma_f32_32x32x16_bf16 v[32:47], a[24:27], v[116:119], v[32:47]
  ds_read_b128 v[116:119], v8 offset:12288
  s_add_u32 m0, s21, 2048
  s_add_u32 s20, s40, 64512
  buffer_load_dwordx4 v5, s[60:63], s20 offen lds
  v_mul_f32 v2, v20, |v20|
  v_mul_f32 v11, v21, |v21|
  s_waitcnt lgkmcnt(4)
  s_nop 0
  v_mfma_f32_32x32x16_bf16 v[32:47], a[28:31], v[48:51], v[32:47]
  ds_read_b128 v[48:51], v9 offset:12288
  v_cvt_pk_bf16_f32 v18, v2, v11
  v_pk_max_i16 v18, v18, 0
  v_mfma_f32_32x32x16_bf16 v[32:47], a[32:35], v[52:55], v[32:47]
  ds_read_b128 v[52:55], v10 offset:12288
  buffer_load_dwordx4 v13, s[60:63], s20 offen offset:1024 lds
  v_mul_f32 v2, v22, |v22|
  v_mul_f32 v11, v23, |v23|
  v_mfma_f32_32x32x16_bf16 v[32:47], a[36:39], v[56:59], v[32:47]
  ds_read_b128 v[56:59], v7 offset:16384
  v_cvt_pk_bf16_f32 v19, v2, v11
  v_pk_max_i16 v19, v19, 0
  s_waitcnt lgkmcnt(4)
  s_nop 0
  v_mfma_f32_32x32x16_bf16 v[32:47], a[40:43], v[60:63], v[32:47]
  ds_read_b128 v[60:63], v8 offset:16384
  s_add_u32 m0, s21, 4096
  s_add_u32 s20, s40, 78848
  buffer_load_dwordx4 v5, s[60:63], s20 offen lds
  buffer_store_dwordx4 v[16:19], v3, s[48:51], s22 offen offset:0 sc1
  v_mul_f32 v2, v24, |v24|
  v_mfma_f32_32x32x16_bf16 v[32:47], a[44:47], v[76:79], v[32:47]
  ds_read_b128 v[76:79], v9 offset:16384
  v_mul_f32 v11, v25, |v25|
  v_cvt_pk_bf16_f32 v24, v2, v11
  v_mfma_f32_32x32x16_bf16 v[32:47], a[48:51], v[112:115], v[32:47]
  ds_read_b128 v[112:115], v10 offset:16384
  v_pk_max_i16 v24, v24, 0
  v_mul_f32 v2, v26, |v26|
  s_waitcnt lgkmcnt(4)
  s_nop 0
  v_mfma_f32_32x32x16_bf16 v[32:47], a[52:55], v[116:119], v[32:47]
  ds_read_b128 v[116:119], v7 offset:20480
  buffer_load_dwordx4 v13, s[60:63], s20 offen offset:1024 lds
  v_mul_f32 v11, v27, |v27|
  v_cvt_pk_bf16_f32 v25, v2, v11
  v_mfma_f32_32x32x16_bf16 v[32:47], a[56:59], v[48:51], v[32:47]
  ds_read_b128 v[48:51], v8 offset:20480
  v_pk_max_i16 v25, v25, 0
  v_mul_f32 v2, v28, |v28|
  v_mfma_f32_32x32x16_bf16 v[32:47], a[60:63], v[52:55], v[32:47]
  ds_read_b128 v[52:55], v9 offset:20480
  s_add_u32 m0, s21, 6144
  s_add_u32 s20, s40, 93184
  buffer_load_dwordx4 v5, s[60:63], s20 offen lds
  v_mul_f32 v11, v29, |v29|
  v_cvt_pk_bf16_f32 v26, v2, v11
  s_waitcnt lgkmcnt(4)
  v_mfma_f32_32x32x16_bf16 v[32:47], a[64:67], v[56:59], v[32:47]
  ds_read_b128 v[56:59], v10 offset:20480
  s_waitcnt vmcnt(16)
  ds_read_b64_tr_b16 a[112:113], v82 offset:28672
  ds_read_b64_tr_b16 a[116:117], v83 offset:28672
  v_pk_max_i16 v26, v26, 0
  v_mul_f32 v2, v30, |v30|
  v_mfma_f32_32x32x16_bf16 v[32:47], a[68:71], v[60:63], v[32:47]
  ds_read_b128 v[60:63], v7 offset:24576
  v_mul_f32 v11, v31, |v31|
  v_cvt_pk_bf16_f32 v27, v2, v11
  v_mfma_f32_32x32x16_bf16 v[32:47], a[72:75], v[76:79], v[32:47]
  ds_read_b128 v[124:127], v14 offset:28816
  ds_read_b128 v[76:79], v8 offset:24576
  s_waitcnt vmcnt(15)
  s_nop 0
  ds_read_b64_tr_b16 a[114:115], v82 offset:29696
  ds_read_b64_tr_b16 a[118:119], v83 offset:29696
  v_pk_max_i16 v27, v27, 0
  buffer_store_dwordx4 v[24:27], v3, s[48:51], s22 offen offset:1024 sc1
  s_waitcnt lgkmcnt(9)
  v_mfma_f32_32x32x16_bf16 v[32:47], a[76:79], v[112:115], v[32:47]
  ds_read_b128 v[112:115], v9 offset:24576
  s_waitcnt vmcnt(15)
  ds_read_b64_tr_b16 a[120:121], v82 offset:30720
  ds_read_b64_tr_b16 a[124:125], v83 offset:30720
  s_waitcnt lgkmcnt(8)
  s_add_u32 m0, s21, 86016
  s_add_u32 s20, s41, 0
  buffer_load_dwordx4 v5, s[60:63], s20 offen lds
  s_add_u32 s22, s22, 114688
  v_mfma_f32_32x32x16_bf16 v[32:47], a[80:83], v[116:119], v[32:47]
  ds_read_b128 v[116:119], v10 offset:24576
  s_mov_b64 exec, 1
  ds_add_u32 v14, v15 offset:49080
  s_mov_b64 exec, -1
  v_mfma_f32_32x32x16_bf16 v[32:47], a[84:87], v[48:51], v[32:47]
  s_waitcnt lgkmcnt(8)
  v_min_u32 v124, v124, v125
  v_min3_u32 v124, v124, v126, v127
  v_cmp_eq_u32 vcc, 0, v124
  s_nop 0
  s_cbranch_vccnz DSL_30
DOK_28:
  v_add_u32 v7, 28672, v7
  ds_read_b128 v[48:51], v7 offset:0
  s_waitcnt vmcnt(15)
  ds_read_b64_tr_b16 a[122:123], v82 offset:31744
  ds_read_b64_tr_b16 a[126:127], v83 offset:31744
  s_waitcnt lgkmcnt(8)
  buffer_load_dwordx4 v13, s[60:63], s20 offen offset:1024 lds
  v_mfma_f32_32x32x16_bf16 v[32:47], a[88:91], v[52:55], v[32:47]
  v_add_u32 v8, 28672, v8
  ds_read_b128 v[52:55], v8 offset:0
  s_waitcnt lgkmcnt(6)
  s_add_u32 m0, s21, 88064
  s_add_u32 s20, s41, 14336
  buffer_load_dwordx4 v5, s[60:63], s20 offen lds
  v_mfma_f32_32x32x16_bf16 v[32:47], a[92:95], v[56:59], v[32:47]
  v_add_u32 v9, 28672, v9
  ds_read_b128 v[56:59], v9 offset:0
  v_mfma_f32_32x32x16_bf16 v[32:47], a[96:99], v[60:63], v[32:47]
  v_add_u32 v10, 28672, v10
  ds_read_b128 v[60:63], v10 offset:0
  s_waitcnt lgkmcnt(3)
  buffer_load_dwordx4 v13, s[60:63], s20 offen offset:1024 lds
  v_mfma_f32_32x32x16_bf16 v[32:47], a[100:103], v[76:79], v[32:47]
  ds_read_b128 v[76:79], v7 offset:4096
  s_waitcnt vmcnt(16)
  ds_read_b64_tr_b16 v[84:85], v82 offset:32768
  ds_read_b64_tr_b16 v[88:89], v83 offset:32768
  v_mfma_f32_32x32x16_bf16 v[32:47], a[104:107], v[112:115], v[32:47]
  v_mfma_f32_32x32x16_bf16 v[32:47], a[108:111], v[116:119], v[32:47]
  s_waitcnt vmcnt(15)
  ds_read_b64_tr_b16 v[86:87], v82 offset:33792
  ds_read_b64_tr_b16 v[90:91], v83 offset:33792
  ds_read_b32 v6, v14 offset:49080
  s_waitcnt lgkmcnt(8)
  v_mfma_f32_32x32x16_bf16 v[16:31], a[0:3], v[48:51], 0
  ds_read_b128 v[48:51], v8 offset:4096
  s_waitcnt vmcnt(14)
  ds_read_b64_tr_b16 v[92:93], v82 offset:34816
  ds_read_b64_tr_b16 v[96:97], v83 offset:34816
  s_waitcnt lgkmcnt(6)
  s_add_u32 m0, s21, 90112
  s_add_u32 s20, s41, 28672
  buffer_load_dwordx4 v5, s[60:63], s20 offen lds
  v_mfma_f32_32x32x16_bf16 v[16:31], v[64:67], v[68:71], v[16:31]
  v_mfma_f32_32x32x16_bf16 v[16:31], a[4:7], v[52:55], v[16:31]
  ds_read_b128 v[52:55], v9 offset:4096
  v_mfma_f32_32x32x16_bf16 v[16:31], a[8:11], v[56:59], v[16:31]
  s_waitcnt lgkmcnt(4)
  v_cmp_gt_u32 vcc, 8, v6
  s_nop 0
  s_cbranch_vccnz CSL_33
COK_31:
  ds_read_b128 v[56:59], v10 offset:4096
  buffer_load_dwordx4 v13, s[60:63], s20 offen offset:1024 lds
  v_mul_f32 v2, v32, |v32|
  v_mul_f32 v11, v33, |v33|
  v_mfma_f32_32x32x16_bf16 v[16:31], a[12:15], v[60:63], v[16:31]
  ds_read_b128 v[60:63], v7 offset:8192
  s_waitcnt lgkmcnt(3)
  s_nop 0
  s_add_u32 m0, s21, 92160
  s_add_u32 s20, s41, 43008
  buffer_load_dwordx4 v5, s[60:63], s20 offen lds
  v_cvt_pk_bf16_f32 v32, v2, v11
  v_pk_max_i16 v32, v32, 0
  v_mfma_f32_32x32x16_bf16 v[16:31], a[16:19], v[76:79], v[16:31]
  ds_read_b128 v[76:79], v8 offset:8192
  v_mul_f32 v2, v34, |v34|
  v_mul_f32 v11, v35, |v35|
  v_mfma_f32_32x32x16_bf16 v[16:31], a[20:23], v[48:51], v[16:31]
  ds_read_b128 v[48:51], v9 offset:8192
  s_add_u32 m0, s21, 28672
  s_add_u32 s20, s42, 0
  buffer_load_dwordx4 v5, s[60:63], s20 offen lds
  v_cvt_pk_bf16_f32 v33, v2, v11
  v_pk_max_i16 v33, v33, 0
  s_waitcnt lgkmcnt(3)
  v_mfma_f32_32x32x16_bf16 v[16:31], a[24:27], v[52:55], v[16:31]
  ds_read_b128 v[52:55], v10 offset:8192
  v_mul_f32 v2, v36, |v36|
  v_mul_f32 v11, v37, |v37|
  v_mfma_f32_32x32x16_bf16 v[16:31], a[28:31], v[56:59], v[16:31]
  ds_read_b128 v[56:59], v7 offset:12288
  buffer_load_dwordx4 v13, s[60:63], s20 offen offset:1024 lds
  v_cvt_pk_bf16_f32 v34, v2, v11
  v_pk_max_i16 v34, v34, 0
  s_waitcnt lgkmcnt(3)
  s_nop 0
  v_mfma_f32_32x32x16_bf16 v[16:31], a[32:35], v[60:63], v[16:31]
  ds_read_b128 v[60:63], v8 offset:12288
  v_mul_f32 v2, v38, |v38|
  v_mul_f32 v11, v39, |v39|
  v_mfma_f32_32x32x16_bf16 v[16:31], a[36:39], v[76:79], v[16:31]
  ds_read_b128 v[76:79], v9 offset:12288
  s_add_u32 m0, s21, 30720
  s_add_u32 s20, s42, 14336
  buffer_load_dwordx4 v5, s[60:63], s20 offen lds
  v_cvt_pk_bf16_f32 v35, v2, v11
  v_pk_max_i16 v35, v35, 0
  s_waitcnt lgkmcnt(3)
  s_nop 0
  v_mfma_f32_32x32x16_bf16 v[16:31], a[40:43], v[48:51], v[16:31]
  ds_read_b128 v[48:51], v10 offset:12288
  buffer_load_dwordx4 v13, s[60:63], s20 offen offset:1024 lds
  buffer_store_dwordx4 v[32:35], v3, s[48:51], s22 offen offset:0 sc1
  v_mul_f32 v2, v40, |v40|
  v_mfma_f32_32x32x16_bf16 v[16:31], a[44:47], v[52:55], v[16:31]
  ds_read_b128 v[52:55], v7 offset:16384
  v_mul_f32 v11, v41, |v41|
  v_cvt_pk_bf16_f32 v40, v2, v11
  s_waitcnt lgkmcnt(3)
  v_mfma_f32_32x32x16_bf16 v[16:31], a[48:51], v[56:59], v[16:31]
  ds_read_b128 v[56:59], v8 offset:16384
  s_waitcnt vmcnt(20)
  ds_read_b64_tr_b16 v[94:95], v80 offset:0
  ds_read_b64_tr_b16 v[98:99], v81 offset:0
  s_waitcnt vmcnt(12)
  s_mov_b32 s91, 1
  s_buffer_atomic_add s91, s[48:51], s25
  s_add_u32 s25, s25, 512
  v_pk_max_i16 v40, v40, 0
  v_mul_f32 v2, v42, |v42|
  v_mfma_f32_32x32x16_bf16 v[16:31], a[52:55], v[60:63], v[16:31]
  ds_read_b128 v[60:63], v9 offset:16384
  ds_read_b64_tr_b16 v[100:101], v80 offset:1024
  ds_read_b64_tr_b16 v[104:105], v81 offset:1024
  v_mul_f32 v11, v43, |v43|
  v_cvt_pk_bf16_f32 v41, v2, v11
  s_waitcnt lgkmcnt(7)
  s_nop 0
  v_mfma_f32_32x32x16_bf16 v[16:31], a[56:59], v[76:79], v[16:31]
  ds_read_b128 v[76:79], v10 offset:16384
  s_add_u32 m0, s21, 32768
  s_add_u32 s20, s42, 28672
  buffer_load_dwordx4 v5, s[60:63], s20 offen lds
  v_pk_max_i16 v41, v41, 0
  v_mul_f32 v2, v44, |v44|
  v_mfma_f32_32x32x16_bf16 v[16:31], a[60:63], v[48:51], v[16:31]
  ds_read_b128 v[48:51], v7 offset:20480
  ds_read_b64_tr_b16 v[102:103], v80 offset:2048
  ds_read_b64_tr_b16 v[106:107], v81 offset:2048
  v_mul_f32 v11, v45, |v45|
  v_cvt_pk_bf16_f32 v42, v2, v11
  s_waitcnt lgkmcnt(9)
  s_nop 0
  v_mfma_f32_32x32x16_bf16 v[16:31], a[64:67], v[52:55], v[16:31]
  ds_read_b128 v[52:55], v8 offset:20480
  s_waitcnt lgkmcnt(8)
  s_add_u32 m0, s21, 0
  s_add_u32 s20, s41, 50176
  buffer_load_dwordx4 v5, s[60:63], s20 offen lds
  v_pk_max_i16 v42, v42, 0
  v_mul_f32 v2, v46, |v46|
  v_mfma_f32_32x32x16_bf16 v[16:31], a[68:71], v[56:59], v[16:31]
  ds_read_b128 v[56:59], v9 offset:20480
  ds_read_b64_tr_b16 v[108:109], v80 offset:3072
  ds_read_b64_tr_b16 v[112:113], v81 offset:3072
  v_mul_f32 v11, v47, |v47|
  v_cvt_pk_bf16_f32 v43, v2, v11
  s_waitcnt lgkmcnt(7)
  s_nop 0
  v_mfma_f32_32x32x16_bf16 v[16:31], a[72:75], v[60:63], v[16:31]
  ds_read_b128 v[60:63], v10 offset:20480
  buffer_load_dwordx4 v13, s[60:63], s20 offen offset:1024 lds
  v_pk_max_i16 v43, v43, 0
  buffer_store_dwordx4 v[40:43], v3, s[48:51], s22 offen offset:1024 sc1
  v_mfma_f32_32x32x16_bf16 v[16:31], a[76:79], v[76:79], v[16:31]
  ds_read_b128 v[76:79], v7 offset:24576
  ds_read_b64_tr_b16 v[110:111], v80 offset:4096
  ds_read_b64_tr_b16 v[114:115], v81 offset:4096
  s_add_u32 s22, s22, 114688
  s_waitcnt lgkmcnt(7)
  s_nop 0
  v_mfma_f32_32x32x16_bf16 v[16:31], a[80:83], v[48:51], v[16:31]
  ds_read_b128 v[48:51], v8 offset:24576
  v_mfma_f32_32x32x16_bf16 v[16:31], a[84:87], v[52:55], v[16:31]
  ds_read_b128 v[52:55], v9 offset:24576
  s_add_u32 m0, s21, 2048
  s_add_u32 s20, s41, 64512
  buffer_load_dwordx4 v5, s[60:63], s20 offen lds
  s_waitcnt lgkmcnt(5)
  v_mfma_f32_32x32x16_bf16 v[16:31], a[88:91], v[56:59], v[16:31]
  ds_read_b128 v[56:59], v10 offset:24576
  s_mov_b64 exec, 1
  ds_add_u32 v14, v15 offset:49080
  s_mov_b64 exec, -1
  ds_read_b64_tr_b16 v[116:117], v80 offset:5120
  ds_read_b64_tr_b16 v[120:121], v81 offset:5120
  v_mfma_f32_32x32x16_bf16 v[16:31], a[92:95], v[60:63], v[16:31]
  buffer_load_dwordx4 v13, s[60:63], s20 offen offset:1024 lds
  s_waitcnt lgkmcnt(5)
  v_mfma_f32_32x32x16_bf16 v[16:31], a[96:99], v[76:79], v[16:31]
  ds_read_b64_tr_b16 v[118:119], v80 offset:6144
  ds_read_b64_tr_b16 v[122:123], v81 offset:6144
  v_mfma_f32_32x32x16_bf16 v[16:31], a[100:103], v[48:51], v[16:31]
  s_add_u32 m0, s21, 4096
  s_add_u32 s20, s41, 78848
  buffer_load_dwordx4 v5, s[60:63], s20 offen lds
  s_waitcnt lgkmcnt(5)
  v_mfma_f32_32x32x16_bf16 v[16:31], a[104:107], v[52:55], v[16:31]
  ds_read_b32 v6, v14 offset:49080
  s_waitcnt lgkmcnt(3)
  buffer_load_dwordx4 v13, s[60:63], s20 offen offset:1024 lds
  v_mfma_f32_32x32x16_bf16 v[16:31], a[108:111], v[56:59], v[16:31]
  ds_read_b32 v12, v14
  s_waitcnt lgkmcnt(1)
  v_cmp_gt_u32 vcc, 12, v6
  s_nop 0
  s_cbranch_vccz COK_34
  s_mov_b32 s66, 0x2000000
CLP_35:
  ds_read_b32 v6, v14 offset:49080
  s_waitcnt lgkmcnt(0)
  v_cmp_gt_u32 vcc, 12, v6
  s_sub_u32 s66, s66, 1
  s_cbranch_scc1 COK_34
  s_cbranch_vccnz CLP_35
COK_34:
  s_buffer_load_dword s76, s[48:51], s23 glc
  s_nop 5
  v_mul_f32 v2, v16, |v16|
  v_mul_f32 v11, v17, |v17|
  v_cvt_pk_bf16_f32 v16, v2, v11
  v_pk_max_i16 v16, v16, 0
  v_mul_f32 v2, v18, |v18|
  v_mul_f32 v11, v19, |v19|
  v_cvt_pk_bf16_f32 v17, v2, v11
  v_pk_max_i16 v17, v17, 0
  v_mul_f32 v2, v20, |v20|
  v_mul_f32 v11, v21, |v21|
  v_cvt_pk_bf16_f32 v18, v2, v11
  v_pk_max_i16 v18, v18, 0
  v_mul_f32 v2, v22, |v22|
  v_mul_f32 v11, v23, |v23|
  v_cvt_pk_bf16_f32 v19, v2, v11
  v_pk_max_i16 v19, v19, 0
  buffer_store_dwordx4 v[16:19], v3, s[48:51], s22 offen offset:0 sc1
  v_mul_f32 v2, v24, |v24|
  v_mul_f32 v11, v25, |v25|
  v_cvt_pk_bf16_f32 v24, v2, v11
  v_pk_max_i16 v24, v24, 0
  v_mul_f32 v2, v26, |v26|
  v_mul_f32 v11, v27, |v27|
  v_cvt_pk_bf16_f32 v25, v2, v11
  v_pk_max_i16 v25, v25, 0
  v_mul_f32 v2, v28, |v28|
  v_mul_f32 v11, v29, |v29|
  v_cvt_pk_bf16_f32 v26, v2, v11
  v_pk_max_i16 v26, v26, 0
  v_mul_f32 v2, v30, |v30|
  v_mul_f32 v11, v31, |v31|
  v_cvt_pk_bf16_f32 v27, v2, v11
  v_pk_max_i16 v27, v27, 0
  buffer_store_dwordx4 v[24:27], v3, s[48:51], s22 offen offset:1024 sc1
  s_add_u32 s22, s22, 114688
  s_add_u32 m0, s21, 6144
  s_add_u32 s20, s41, 93184
  buffer_load_dwordx4 v5, s[60:63], s20 offen lds
  s_add_u32 m0, s21, 33792
  s_add_u32 s20, s42, 35840
  buffer_load_dwordx4 v5, s[60:63], s20 offen lds
  buffer_load_dwordx4 v13, s[60:63], s20 offen offset:1024 lds
  s_waitcnt vmcnt(17)
  s_nop 0
  ds_read_b64_tr_b16 a[0:1], v80 offset:28672
  ds_read_b64_tr_b16 a[4:5], v81 offset:28672
  s_add_u32 m0, s21, 57344
  s_add_u32 s20, s42, 50176
  buffer_load_dwordx4 v5, s[60:63], s20 offen lds
  s_waitcnt vmcnt(17)
  ds_read_b64_tr_b16 a[2:3], v80 offset:29696
  ds_read_b64_tr_b16 a[6:7], v81 offset:29696
  buffer_load_dwordx4 v13, s[60:63], s20 offen offset:1024 lds
  s_waitcnt vmcnt(17)
  ds_read_b64_tr_b16 a[8:9], v80 offset:30720
  ds_read_b64_tr_b16 a[12:13], v81 offset:30720
  s_add_u32 m0, s21, 59392
  s_add_u32 s20, s42, 64512
  buffer_load_dwordx4 v5, s[60:63], s20 offen lds
  s_waitcnt vmcnt(17)
  ds_read_b64_tr_b16 a[10:11], v80 offset:31744
  ds_read_b64_tr_b16 a[14:15], v81 offset:31744
  buffer_load_dwordx4 v13, s[60:63], s20 offen offset:1024 lds
  s_waitcnt lgkmcnt(0)
  s_sub_u32 s76, s76, s64
  s_cmp_eq_u32 s76, 14
  s_cbranch_scc1 KOK_37
  s_mov_b32 s66, 0x100000
KLP_38:
  s_sleep 2
  s_buffer_load_dword s76, s[48:51], s23 glc
  s_waitcnt lgkmcnt(0)
  s_sub_u32 s76, s76, s64
  s_cmp_eq_u32 s76, 14
  s_cbranch_scc1 KOK_37
  s_sub_u32 s66, s66, 1
  s_cbranch_scc0 KLP_38
KOK_37:
  s_mov_b32 s37, s27
  s_add_u32 s27, s44, 0
  buffer_load_dwordx4 v[48:51], v3, s[48:51], s27 offen offset:0 sc1
  buffer_load_dwordx4 v[52:55], v3, s[48:51], s27 offen offset:1024 sc1
  buffer_load_dwordx4 v[56:59], v3, s[48:51], s27 offen offset:2048 sc1
  s_waitcnt vmcnt(10)
  s_mov_b32 s91, 1
  s_buffer_atomic_add s91, s[48:51], s25
  buffer_load_dwordx4 v[60:63], v3, s[48:51], s27 offen offset:3072 sc1
  s_add_u32 s27, s44, 4096
  buffer_load_dwordx4 v[64:67], v3, s[48:51], s27 offen offset:0 sc1
  buffer_load_dwordx4 v[68:71], v3, s[48:51], s27 offen offset:1024 sc1
  buffer_load_dwordx4 v[72:75], v3, s[48:51], s27 offen offset:2048 sc1
  s_add_u32 s27, s45, 0
  buffer_load_dwordx4 v[76:79], v3, s[48:51], s27 offen offset:0 sc1
  buffer_load_dwordx4 v[124:127], v3, s[48:51], s27 offen offset:1024 sc1
  buffer_load_dwordx4 a[104:107], v3, s[48:51], s27 offen offset:2048 sc1
  buffer_load_dwordx4 a[108:111], v3, s[48:51], s27 offen offset:3072 sc1
  s_setprio 0
  v_add_u32 v4, s21, v3
  s_lshl_b32 s8, s3, 12
  v_add_u32 v7, s8, v3
  s_add_u32 s23, s23, 512
  s_waitcnt vmcnt(10)
  v_mfma_f32_32x32x16_bf16 a[56:71], a[112:115], v[48:51], 0
  v_mfma_f32_32x32x16_bf16 a[72:87], a[116:119], v[48:51], 0
  ds_read_b64_tr_b16 a[16:17], v80 offset:32768
  ds_read_b64_tr_b16 a[20:21], v81 offset:32768
  s_add_u32 m0, s21, 61440
  s_add_u32 s20, s42, 78848
  buffer_load_dwordx4 v5, s[60:63], s20 offen lds
  buffer_load_dwordx4 v13, s[60:63], s20 offen offset:1024 lds
  s_add_u32 s27, s45, 4096
  buffer_load_dwordx4 v[48:51], v3, s[48:51], s27 offen offset:0 sc1
  s_waitcnt vmcnt(12)
  s_nop 0
  v_mfma_f32_32x32x16_bf16 a[56:71], a[120:123], v[52:55], a[56:71]
  v_mfma_f32_32x32x16_bf16 a[72:87], a[124:127], v[52:55], a[72:87]
  s_add_u32 m0, s21, 63488
  s_add_u32 s20, s42, 93184
  buffer_load_dwordx4 v5, s[60:63], s20 offen lds
  ds_read_b64_tr_b16 a[18:19], v80 offset:33792
  ds_read_b64_tr_b16 a[22:23], v81 offset:33792
  s_add_u32 m0, s21, 28672
  s_add_u32 s20, s43, 0
  buffer_load_dwordx4 v5, s[60:63], s20 offen lds
  buffer_load_dwordx4 v[52:55], v3, s[48:51], s27 offen offset:1024 sc1
  s_waitcnt vmcnt(14)
  v_mfma_f32_32x32x16_bf16 a[56:71], v[84:87], v[56:59], a[56:71]
  v_mfma_f32_32x32x16_bf16 a[72:87], v[88:91], v[56:59], a[72:87]
  ds_read_b64_tr_b16 a[24:25], v80 offset:34816
  ds_read_b64_tr_b16 a[28:29], v81 offset:34816
  buffer_load_dwordx4 v13, s[60:63], s20 offen offset:1024 lds
  ds_read_b64_tr_b16 a[26:27], v82 offset:0
  ds_read_b64_tr_b16 a[30:31], v83 offset:0
  s_add_u32 m0, s21, 30720
  s_add_u32 s20, s43, 14336
  buffer_load_dwordx4 v5, s[60:63], s20 offen lds
  buffer_load_dwordx4 v[56:59], v3, s[48:51], s27 offen offset:2048 sc1
  s_waitcnt vmcnt(16)
  v_mfma_f32_32x32x16_bf16 a[56:71], v[92:95], v[60:63], a[56:71]
  v_mfma_f32_32x32x16_bf16 a[72:87], v[96:99], v[60:63], a[72:87]
  ds_read_b64_tr_b16 a[32:33], v82 offset:1024
  ds_read_b64_tr_b16 a[36:37], v83 offset:1024
  buffer_load_dwordx4 v13, s[60:63], s20 offen offset:1024 lds
  ds_read_b64_tr_b16 a[34:35], v82 offset:2048
  ds_read_b64_tr_b16 a[38:39], v83 offset:2048
  s_waitcnt lgkmcnt(10)
  s_add_u32 m0, s21, 32768
  s_add_u32 s20, s43, 28672
  buffer_load_dwordx4 v5, s[60:63], s20 offen lds
  s_add_u32 s27, s46, 0
  buffer_load_dwordx4 v[60:63], v3, s[48:51], s27 offen offset:0 sc1
  s_waitcnt vmcnt(18)
  v_mfma_f32_32x32x16_bf16 a[56:71], v[100:103], v[64:67], a[56:71]
  v_mfma_f32_32x32x16_bf16 a[72:87], v[104:107], v[64:67], a[72:87]
  ds_read_b64_tr_b16 a[40:41], v82 offset:3072
  ds_read_b64_tr_b16 a[44:45], v83 offset:3072
  s_waitcnt lgkmcnt(10)
  buffer_load_dwordx4 v13, s[60:63], s20 offen offset:1024 lds
  s_waitcnt lgkmcnt(8)
  s_add_u32 m0, s21, 34816
  s_add_u32 s20, s43, 43008
  buffer_load_dwordx4 v5, s[60:63], s20 offen lds
  buffer_load_dwordx4 v[64:67], v3, s[48:51], s27 offen offset:1024 sc1
  s_waitcnt vmcnt(20)
  v_mfma_f32_32x32x16_bf16 a[56:71], v[108:111], v[68:71], a[56:71]
  v_mfma_f32_32x32x16_bf16 a[72:87], v[112:115], v[68:71], a[72:87]
  s_waitcnt lgkmcnt(6)
  s_add_u32 m0, s21, 57344
  s_add_u32 s20, s43, 50176
  buffer_load_dwordx4 v5, s[60:63], s20 offen lds
  s_waitcnt lgkmcnt(4)
  buffer_load_dwordx4 v13, s[60:63], s20 offen offset:1024 lds
  buffer_load_dwordx4 v[68:71], v3, s[48:51], s27 offen offset:2048 sc1
  ds_read_b64_tr_b16 v[40:41], v82 offset:28672
  ds_read_b64_tr_b16 v[44:45], v83 offset:28672
  ds_read_b64_tr_b16 v[42:43], v82 offset:29696
  ds_read_b64_tr_b16 v[46:47], v83 offset:29696
  s_waitcnt vmcnt(22)
  v_mfma_f32_32x32x16_bf16 a[56:71], v[116:119], v[72:75], a[56:71]
  v_mfma_f32_32x32x16_bf16 a[72:87], v[120:123], v[72:75], a[72:87]
  s_waitcnt lgkmcnt(6)
  s_add_u32 m0, s21, 59392
  s_add_u32 s20, s43, 64512
  buffer_load_dwordx4 v5, s[60:63], s20 offen lds
  s_waitcnt lgkmcnt(4)
  buffer_load_dwordx4 v13, s[60:63], s20 offen offset:1024 lds
  buffer_load_dwordx4 v[72:75], v3, s[48:51], s27 offen offset:3072 sc1
  ds_read_b64_tr_b16 v[32:33], v82 offset:30720
  ds_read_b64_tr_b16 v[36:37], v83 offset:30720
  ds_read_b64_tr_b16 v[34:35], v82 offset:31744
  ds_read_b64_tr_b16 v[38:39], v83 offset:31744
  s_waitcnt vmcnt(24) lgkmcnt(5)
  v_mfma_f32_32x32x16_bf16 a[56:71], v[40:43], v[76:79], a[56:71]
  s_waitcnt lgkmcnt(4)
  v_mfma_f32_32x32x16_bf16 a[72:87], v[44:47], v[76:79], a[72:87]
  s_waitcnt vmcnt(20)
  ds_read_b64_tr_b16 a[42:43], v82 offset:4096
  ds_read_b64_tr_b16 a[46:47], v83 offset:4096
  s_waitcnt vmcnt(19)
  ds_read_b64_tr_b16 a[48:49], v82 offset:5120
  ds_read_b64_tr_b16 a[52:53], v83 offset:5120
  s_add_u32 s27, s46, 4096
  buffer_load_dwordx4 v[76:79], v3, s[48:51], s27 offen offset:0 sc1
  ds_read_b64_tr_b16 v[40:41], v82 offset:32768
  ds_read_b64_tr_b16 v[44:45], v83 offset:32768
  ds_read_b64_tr_b16 v[42:43], v82 offset:33792
  ds_read_b64_tr_b16 v[46:47], v83 offset:33792
  s_waitcnt lgkmcnt(9)
  v_mfma_f32_32x32x16_bf16 a[56:71], v[32:35], v[124:127], a[56:71]
  s_waitcnt lgkmcnt(8)
  v_mfma_f32_32x32x16_bf16 a[72:87], v[36:39], v[124:127], a[72:87]
  s_waitcnt vmcnt(18)
  ds_read_b64_tr_b16 a[50:51], v82 offset:6144
  ds_read_b64_tr_b16 a[54:55], v83 offset:6144
  s_waitcnt lgkmcnt(8)
  s_add_u32 m0, s21, 61440
  s_add_u32 s20, s43, 78848
  buffer_load_dwordx4 v5, s[60:63], s20 offen lds
  s_waitcnt lgkmcnt(6)
  buffer_load_dwordx4 v13, s[60:63], s20 offen offset:1024 lds
  buffer_load_dwordx4 v[124:127], v3, s[48:51], s27 offen offset:1024 sc1
  ds_read_b64_tr_b16 v[32:33], v82 offset:34816
  ds_read_b64_tr_b16 v[36:37], v83 offset:34816
  ds_read_b64_tr_b16 v[34:35], v80 offset:0
  ds_read_b64_tr_b16 v[38:39], v81 offset:0
  s_waitcnt lgkmcnt(7)
  v_mfma_f32_32x32x16_bf16 a[56:71], v[40:43], a[104:107], a[56:71]
  s_waitcnt lgkmcnt(6)
  v_mfma_f32_32x32x16_bf16 a[72:87], v[44:47], a[104:107], a[72:87]
  s_waitcnt lgkmcnt(4)
  s_add_u32 m0, s21, 63488
  s_add_u32 s20, s43, 93184
  buffer_load_dwordx4 v5, s[60:63], s20 offen lds
  buffer_load_dwordx4 a[104:107], v3, s[48:51], s27 offen offset:2048 sc1
  ds_read_b64_tr_b16 v[40:41], v80 offset:1024
  ds_read_b64_tr_b16 v[44:45], v81 offset:1024
  ds_read_b64_tr_b16 v[42:43], v80 offset:2048
  ds_read_b64_tr_b16 v[46:47], v81 offset:2048
  s_waitcnt lgkmcnt(5)
  s_nop 0
  v_mfma_f32_32x32x16_bf16 a[56:71], v[32:35], a[108:111], a[56:71]
  s_waitcnt lgkmcnt(4)
  v_mfma_f32_32x32x16_bf16 a[72:87], v[36:39], a[108:111], a[72:87]
  s_add_u32 s27, s47, 0
  buffer_load_dwordx4 a[108:111], v3, s[48:51], s27 offen offset:0 sc1
  ds_read_b64_tr_b16 v[32:33], v80 offset:3072
  ds_read_b64_tr_b16 v[36:37], v81 offset:3072
  ds_read_b64_tr_b16 v[34:35], v80 offset:4096
  ds_read_b64_tr_b16 v[38:39], v81 offset:4096
  s_waitcnt lgkmcnt(5)
  v_mfma_f32_32x32x16_bf16 a[56:71], v[40:43], v[48:51], a[56:71]
  s_waitcnt lgkmcnt(4)
  v_mfma_f32_32x32x16_bf16 a[72:87], v[44:47], v[48:51], a[72:87]
  buffer_load_dwordx4 v[48:51], v3, s[48:51], s27 offen offset:1024 sc1
  ds_read_b64_tr_b16 v[40:41], v80 offset:5120
  ds_read_b64_tr_b16 v[44:45], v81 offset:5120
  ds_read_b64_tr_b16 v[42:43], v80 offset:6144
  ds_read_b64_tr_b16 v[46:47], v81 offset:6144
  s_waitcnt vmcnt(23) lgkmcnt(5)
  v_mfma_f32_32x32x16_bf16 a[56:71], v[32:35], v[52:55], a[56:71]
  s_waitcnt lgkmcnt(4)
  v_mfma_f32_32x32x16_bf16 a[72:87], v[36:39], v[52:55], a[72:87]
  buffer_load_dwordx4 v[52:55], v3, s[48:51], s27 offen offset:2048 sc1
  s_waitcnt vmcnt(21) lgkmcnt(1)
  v_mfma_f32_32x32x16_bf16 a[56:71], v[40:43], v[56:59], a[56:71]
  ds_read_b32 v12, v14
  s_waitcnt lgkmcnt(1)
  v_mfma_f32_32x32x16_bf16 a[72:87], v[44:47], v[56:59], a[72:87]
  s_buffer_load_dword s76, s[48:51], s23 glc
  buffer_load_dwordx4 v[56:59], v3, s[48:51], s27 offen offset:3072 sc1
  s_waitcnt vmcnt(19)
  s_nop 0
  v_mfma_f32_32x32x16_bf16 a[56:71], a[0:3], v[60:63], a[56:71]
  v_mfma_f32_32x32x16_bf16 a[72:87], a[4:7], v[60:63], a[72:87]
  s_add_u32 s27, s47, 4096
  buffer_load_dwordx4 v[60:63], v3, s[48:51], s27 offen offset:0 sc1
  s_waitcnt vmcnt(17)
  v_mfma_f32_32x32x16_bf16 a[56:71], a[8:11], v[64:67], a[56:71]
  v_mfma_f32_32x32x16_bf16 a[72:87], a[12:15], v[64:67], a[72:87]
  buffer_load_dwordx4 v[64:67], v3, s[48:51], s27 offen offset:1024 sc1
  s_waitcnt vmcnt(15)
  v_mfma_f32_32x32x16_bf16 a[56:71], a[16:19], v[68:71], a[56:71]
  v_mfma_f32_32x32x16_bf16 a[72:87], a[20:23], v[68:71], a[72:87]
  s_waitcnt lgkmcnt(0)
  s_sub_u32 s76, s76, s64
  s_cmp_eq_u32 s76, 14
  s_cbranch_scc1 KOK_40
  s_mov_b32 s66, 0x100000
KLP_41:
  s_sleep 2
  s_buffer_load_dword s76, s[48:51], s23 glc
  s_waitcnt lgkmcnt(0)
  s_sub_u32 s76, s76, s64
  s_cmp_eq_u32 s76, 14
  s_cbranch_scc1 KOK_40
  s_sub_u32 s66, s66, 1
  s_cbranch_scc0 KLP_41
KOK_40:
  buffer_load_dwordx4 v[68:71], v3, s[48:51], s27 offen offset:2048 sc1
  s_waitcnt vmcnt(13)
  v_mfma_f32_32x32x16_bf16 a[56:71], a[24:27], v[72:75], a[56:71]
  v_mfma_f32_32x32x16_bf16 a[72:87], a[28:31], v[72:75], a[72:87]
  s_add_u32 s27, s44, 229376
  buffer_load_dwordx4 v[72:75], v3, s[48:51], s27 offen offset:0 sc1
  s_waitcnt vmcnt(13)
  v_mfma_f32_32x32x16_bf16 a[56:71], a[32:35], v[76:79], a[56:71]
  v_mfma_f32_32x32x16_bf16 a[72:87], a[36:39], v[76:79], a[72:87]
  buffer_load_dwordx4 v[76:79], v3, s[48:51], s27 offen offset:1024 sc1
  s_waitcnt vmcnt(11)
  v_mfma_f32_32x32x16_bf16 a[56:71], a[40:43], v[124:127], a[56:71]
  v_mfma_f32_32x32x16_bf16 a[72:87], a[44:47], v[124:127], a[72:87]
  buffer_load_dwordx4 v[124:127], v3, s[48:51], s27 offen offset:2048 sc1
  ds_read_b64_tr_b16 v[40:41], v80 offset:28672
  ds_read_b64_tr_b16 v[44:45], v81 offset:28672
  ds_read_b64_tr_b16 v[42:43], v80 offset:29696
  ds_read_b64_tr_b16 v[46:47], v81 offset:29696
  s_waitcnt vmcnt(10)
  s_nop 0
  v_mfma_f32_32x32x16_bf16 a[56:71], a[48:51], a[104:107], a[56:71]
  v_mfma_f32_32x32x16_bf16 a[72:87], a[52:55], a[104:107], a[72:87]
  buffer_load_dwordx4 a[104:107], v3, s[48:51], s27 offen offset:3072 sc1
  ds_read_b64_tr_b16 v[32:33], v80 offset:30720
  ds_read_b64_tr_b16 v[36:37], v81 offset:30720
  ds_read_b64_tr_b16 v[34:35], v80 offset:31744
  ds_read_b64_tr_b16 v[38:39], v81 offset:31744
  s_waitcnt vmcnt(10) lgkmcnt(5)
  v_mfma_f32_32x32x16_bf16 a[56:71], v[40:43], a[108:111], a[56:71]
  s_waitcnt lgkmcnt(4)
  v_mfma_f32_32x32x16_bf16 a[72:87], v[44:47], a[108:111], a[72:87]
  s_add_u32 s27, s44, 233472
  buffer_load_dwordx4 a[108:111], v3, s[48:51], s27 offen offset:0 sc1
  ds_read_b64_tr_b16 v[40:41], v80 offset:32768
  ds_read_b64_tr_b16 v[44:45], v81 offset:32768
  ds_read_b64_tr_b16 v[42:43], v80 offset:33792
  ds_read_b64_tr_b16 v[46:47], v81 offset:33792
  s_waitcnt vmcnt(10) lgkmcnt(5)
  v_mfma_f32_32x32x16_bf16 a[56:71], v[32:35], v[48:51], a[56:71]
  s_waitcnt lgkmcnt(4)
  v_mfma_f32_32x32x16_bf16 a[72:87], v[36:39], v[48:51], a[72:87]
  buffer_load_dwordx4 v[48:51], v3, s[48:51], s27 offen offset:1024 sc1
  ds_read_b64_tr_b16 v[32:33], v80 offset:34816
  ds_read_b64_tr_b16 v[36:37], v81 offset:34816
  ds_read_b64_tr_b16 v[34:35], v82 offset:0
  ds_read_b64_tr_b16 v[38:39], v83 offset:0
  s_waitcnt vmcnt(10) lgkmcnt(5)
  v_mfma_f32_32x32x16_bf16 a[56:71], v[40:43], v[52:55], a[56:71]
  s_waitcnt lgkmcnt(4)
  v_mfma_f32_32x32x16_bf16 a[72:87], v[44:47], v[52:55], a[72:87]
  buffer_load_dwordx4 v[52:55], v3, s[48:51], s27 offen offset:2048 sc1
  ds_read_b64_tr_b16 v[40:41], v82 offset:1024
  ds_read_b64_tr_b16 v[44:45], v83 offset:1024
  ds_read_b64_tr_b16 v[42:43], v82 offset:2048
  ds_read_b64_tr_b16 v[46:47], v83 offset:2048
  s_waitcnt vmcnt(10) lgkmcnt(5)
  v_mfma_f32_32x32x16_bf16 a[56:71], v[32:35], v[56:59], a[56:71]
  s_waitcnt lgkmcnt(4)
  v_mfma_f32_32x32x16_bf16 a[72:87], v[36:39], v[56:59], a[72:87]
  s_add_u32 s27, s45, 229376
  buffer_load_dwordx4 v[56:59], v3, s[48:51], s27 offen offset:0 sc1
  s_mov_b64 exec, 1
  ds_add_u32 v14, v15 offset:49068
  s_mov_b64 exec, -1
  ds_read_b64_tr_b16 v[32:33], v82 offset:3072
  ds_read_b64_tr_b16 v[36:37], v83 offset:3072
  ds_read_b64_tr_b16 v[34:35], v82 offset:4096
  ds_read_b64_tr_b16 v[38:39], v83 offset:4096
  s_waitcnt vmcnt(10) lgkmcnt(6)
  v_mfma_f32_32x32x16_bf16 a[56:71], v[40:43], v[60:63], a[56:71]
  s_waitcnt lgkmcnt(5)
  v_mfma_f32_32x32x16_bf16 a[72:87], v[44:47], v[60:63], a[72:87]
  buffer_load_dwordx4 v[60:63], v3, s[48:51], s27 offen offset:1024 sc1
  ds_read_b64_tr_b16 v[40:41], v82 offset:5120
  ds_read_b64_tr_b16 v[44:45], v83 offset:5120
  ds_read_b64_tr_b16 v[42:43], v82 offset:6144
  ds_read_b64_tr_b16 v[46:47], v83 offset:6144
  s_waitcnt vmcnt(10) lgkmcnt(5)
  v_mfma_f32_32x32x16_bf16 a[56:71], v[32:35], v[64:67], a[56:71]
  s_waitcnt lgkmcnt(4)
  v_mfma_f32_32x32x16_bf16 a[72:87], v[36:39], v[64:67], a[72:87]
  buffer_load_dwordx4 v[64:67], v3, s[48:51], s27 offen offset:2048 sc1
  s_waitcnt vmcnt(10) lgkmcnt(1)
  v_mfma_f32_32x32x16_bf16 a[56:71], v[40:43], v[68:71], a[56:71]
  s_waitcnt lgkmcnt(0)
  v_mfma_f32_32x32x16_bf16 a[72:87], v[44:47], v[68:71], a[72:87]
  buffer_load_dwordx4 v[68:71], v3, s[48:51], s27 offen offset:3072 sc1
  s_waitcnt vmcnt(10)
  v_mfma_f32_32x32x16_bf16 a[88:103], a[112:115], v[72:75], 0
  v_mfma_f32_32x32x16_bf16 v[16:31], a[116:119], v[72:75], 0
  s_add_u32 s27, s45, 233472
  buffer_load_dwordx4 v[72:75], v3, s[48:51], s27 offen offset:0 sc1
  ds_read_b32 v6, v14 offset:49056
  s_waitcnt vmcnt(10)
  v_mfma_f32_32x32x16_bf16 a[88:103], a[120:123], v[76:79], a[88:103]
  v_mfma_f32_32x32x16_bf16 v[16:31], a[124:127], v[76:79], v[16:31]
  buffer_load_dwordx4 v[76:79], v3, s[48:51], s27 offen offset:1024 sc1
  s_waitcnt vmcnt(10)
  v_mfma_f32_32x32x16_bf16 a[88:103], v[84:87], v[124:127], a[88:103]
  v_mfma_f32_32x32x16_bf16 v[16:31], v[88:91], v[124:127], v[16:31]
  buffer_load_dwordx4 v[124:127], v3, s[48:51], s27 offen offset:2048 sc1
  s_waitcnt lgkmcnt(0)
  v_cmp_gt_u32 vcc, 4, v6
  s_nop 0
  s_cbranch_vccnz CSL_45
COK_43:
  s_waitcnt vmcnt(10)
  v_mfma_f32_32x32x16_bf16 a[88:103], v[92:95], a[104:107], a[88:103]
  v_mfma_f32_32x32x16_bf16 v[16:31], v[96:99], a[104:107], v[16:31]
  s_add_u32 s27, s46, 229376
  buffer_load_dwordx4 a[104:107], v3, s[48:51], s27 offen offset:0 sc1
  v_xor_b32 v2, 0, v7
  ds_write_b128 v2, a[56:59] offset:0
  s_waitcnt vmcnt(10)
  v_mfma_f32_32x32x16_bf16 a[88:103], v[100:103], a[108:111], a[88:103]
  v_mfma_f32_32x32x16_bf16 v[16:31], v[104:107], a[108:111], v[16:31]
  buffer_load_dwordx4 a[108:111], v3, s[48:51], s27 offen offset:1024 sc1
  v_xor_b32 v2, 32, v7
  ds_write_b128 v2, a[60:63] offset:1024
  s_waitcnt vmcnt(10)
  v_mfma_f32_32x32x16_bf16 a[88:103], v[108:111], v[48:51], a[88:103]
  v_mfma_f32_32x32x16_bf16 v[16:31], v[112:115], v[48:51], v[16:31]
  buffer_load_dwordx4 v[48:51], v3, s[48:51], s27 offen offset:2048 sc1
  v_xor_b32_e64 v2, 64, v7
  ds_write_b128 v2, a[64:67] offset:2048
  ds_read_b64_tr_b16 v[40:41], v82 offset:28672
  ds_read_b64_tr_b16 v[44:45], v83 offset:28672
  ds_read_b64_tr_b16 v[42:43], v82 offset:29696
  ds_read_b64_tr_b16 v[46:47], v83 offset:29696
  s_waitcnt vmcnt(10)
  s_nop 0
  v_mfma_f32_32x32x16_bf16 a[88:103], v[116:119], v[52:55], a[88:103]
  v_mfma_f32_32x32x16_bf16 v[16:31], v[120:123], v[52:55], v[16:31]
  buffer_load_dwordx4 v[52:55], v3, s[48:51], s27 offen offset:3072 sc1
  v_xor_b32 v2, 96, v7
  ds_write_b128 v2, a[68:71] offset:3072
  ds_read_b64_tr_b16 v[32:33], v82 offset:30720
  ds_read_b64_tr_b16 v[36:37], v83 offset:30720
  ds_read_b64_tr_b16 v[34:35], v82 offset:31744
  ds_read_b64_tr_b16 v[38:39], v83 offset:31744
  s_waitcnt vmcnt(10) lgkmcnt(6)
  v_mfma_f32_32x32x16_bf16 a[88:103], v[40:43], v[56:59], a[88:103]
  s_waitcnt lgkmcnt(5)
  v_mfma_f32_32x32x16_bf16 v[16:31], v[44:47], v[56:59], v[16:31]
  s_add_u32 s27, s46, 233472
  buffer_load_dwordx4 v[56:59], v3, s[48:51], s27 offen offset:0 sc1
  ds_read_b64_tr_b16 v[40:41], v82 offset:32768
  ds_read_b64_tr_b16 v[44:45], v83 offset:32768
  ds_read_b64_tr_b16 v[42:43], v82 offset:33792
  ds_read_b64_tr_b16 v[46:47], v83 offset:33792
  s_waitcnt vmcnt(10) lgkmcnt(5)
  v_mfma_f32_32x32x16_bf16 a[88:103], v[32:35], v[60:63], a[88:103]
  s_waitcnt lgkmcnt(4)
  v_mfma_f32_32x32x16_bf16 v[16:31], v[36:39], v[60:63], v[16:31]
  buffer_load_dwordx4 v[60:63], v3, s[48:51], s27 offen offset:1024 sc1
  v_xor_b32_e64 v100, 0, v4
  ds_read_b64_tr_b16 v[32:33], v82 offset:34816
  ds_read_b64_tr_b16 v[36:37], v83 offset:34816
  ds_read_b64_tr_b16 v[34:35], v80 offset:0
  ds_read_b64_tr_b16 v[38:39], v81 offset:0
  s_waitcnt vmcnt(10) lgkmcnt(5)
  v_mfma_f32_32x32x16_bf16 a[88:103], v[40:43], v[64:67], a[88:103]
  s_waitcnt lgkmcnt(4)
  v_mfma_f32_32x32x16_bf16 v[16:31], v[44:47], v[64:67], v[16:31]
  buffer_load_dwordx4 v[64:67], v3, s[48:51], s27 offen offset:2048 sc1
  v_xor_b32_e64 v101, 32, v4
  ds_read_b64_tr_b16 v[40:41], v80 offset:1024
  ds_read_b64_tr_b16 v[44:45], v81 offset:1024
  ds_read_b64_tr_b16 v[42:43], v80 offset:2048
  ds_read_b64_tr_b16 v[46:47], v81 offset:2048
  s_waitcnt vmcnt(10) lgkmcnt(5)
  v_mfma_f32_32x32x16_bf16 a[88:103], v[32:35], v[68:71], a[88:103]
  s_waitcnt lgkmcnt(4)
  v_mfma_f32_32x32x16_bf16 v[16:31], v[36:39], v[68:71], v[16:31]
  s_add_u32 s27, s47, 229376
  buffer_load_dwordx4 v[68:71], v3, s[48:51], s27 offen offset:0 sc1
  v_xor_b32_e64 v102, 64, v4
  ds_read_b64_tr_b16 v[32:33], v80 offset:3072
  ds_read_b64_tr_b16 v[36:37], v81 offset:3072
  ds_read_b64_tr_b16 v[34:35], v80 offset:4096
  ds_read_b64_tr_b16 v[38:39], v81 offset:4096
  s_waitcnt vmcnt(10) lgkmcnt(5)
  v_mfma_f32_32x32x16_bf16 a[88:103], v[40:43], v[72:75], a[88:103]
  s_waitcnt lgkmcnt(4)
  v_mfma_f32_32x32x16_bf16 v[16:31], v[44:47], v[72:75], v[16:31]
  buffer_load_dwordx4 v[72:75], v3, s[48:51], s27 offen offset:1024 sc1
  v_xor_b32 v103, 96, v4
  ds_read_b64_tr_b16 v[40:41], v80 offset:5120
  ds_read_b64_tr_b16 v[44:45], v81 offset:5120
  ds_read_b64_tr_b16 v[42:43], v80 offset:6144
  ds_read_b64_tr_b16 v[46:47], v81 offset:6144
  s_waitcnt vmcnt(10) lgkmcnt(5)
  v_mfma_f32_32x32x16_bf16 a[88:103], v[32:35], v[76:79], a[88:103]
  s_waitcnt lgkmcnt(4)
  v_mfma_f32_32x32x16_bf16 v[16:31], v[36:39], v[76:79], v[16:31]
  buffer_load_dwordx4 v[76:79], v3, s[48:51], s27 offen offset:2048 sc1
  v_xor_b32 v104, 128, v4
  s_waitcnt vmcnt(10) lgkmcnt(1)
  v_mfma_f32_32x32x16_bf16 a[88:103], v[40:43], v[124:127], a[88:103]
  s_waitcnt lgkmcnt(0)
  v_mfma_f32_32x32x16_bf16 v[16:31], v[44:47], v[124:127], v[16:31]
  buffer_load_dwordx4 v[124:127], v3, s[48:51], s27 offen offset:3072 sc1
  v_xor_b32 v105, 160, v4
  s_waitcnt vmcnt(10)
  v_mfma_f32_32x32x16_bf16 a[88:103], a[0:3], a[104:107], a[88:103]
  v_mfma_f32_32x32x16_bf16 v[16:31], a[4:7], a[104:107], v[16:31]
  s_add_u32 s27, s47, 233472
  buffer_load_dwordx4 a[104:107], v3, s[48:51], s27 offen offset:0 sc1
  v_xor_b32 v106, 192, v4
  v_xor_b32 v2, 128, v7
  ds_write_b128 v2, a[72:75] offset:16384
  s_waitcnt vmcnt(10)
  v_mfma_f32_32x32x16_bf16 a[88:103], a[8:11], a[108:111], a[88:103]
  v_mfma_f32_32x32x16_bf16 v[16:31], a[12:15], a[108:111], v[16:31]
  buffer_load_dwordx4 a[108:111], v3, s[48:51], s27 offen offset:1024 sc1
  v_xor_b32 v107, 224, v4
  v_xor_b32 v2, 160, v7
  ds_write_b128 v2, a[76:79] offset:17408
  s_waitcnt vmcnt(10)
  v_mfma_f32_32x32x16_bf16 a[88:103], a[16:19], v[48:51], a[88:103]
  v_mfma_f32_32x32x16_bf16 v[16:31], a[20:23], v[48:51], v[16:31]
  buffer_load_dwordx4 v[48:51], v3, s[48:51], s27 offen offset:2048 sc1
  v_xor_b32 v2, 192, v7
  ds_write_b128 v2, a[80:83] offset:18432
  s_waitcnt vmcnt(10)
  v_mfma_f32_32x32x16_bf16 a[88:103], a[24:27], v[52:55], a[88:103]
  v_mfma_f32_32x32x16_bf16 v[16:31], a[28:31], v[52:55], v[16:31]
  v_xor_b32 v2, 224, v7
  ds_write_b128 v2, a[84:87] offset:19456
  s_waitcnt vmcnt(9)
  v_mfma_f32_32x32x16_bf16 a[88:103], a[32:35], v[56:59], a[88:103]
  v_mfma_f32_32x32x16_bf16 v[16:31], a[36:39], v[56:59], v[16:31]
  s_waitcnt vmcnt(8)
  v_mfma_f32_32x32x16_bf16 a[88:103], a[40:43], v[60:63], a[88:103]
  v_mfma_f32_32x32x16_bf16 v[16:31], a[44:47], v[60:63], v[16:31]
  ds_read_b64_tr_b16 v[40:41], v80 offset:28672
  ds_read_b64_tr_b16 v[44:45], v81 offset:28672
  ds_read_b64_tr_b16 v[42:43], v80 offset:29696
  ds_read_b64_tr_b16 v[46:47], v81 offset:29696
  s_waitcnt vmcnt(7)
  s_nop 0
  v_mfma_f32_32x32x16_bf16 a[88:103], a[48:51], v[64:67], a[88:103]
  v_mfma_f32_32x32x16_bf16 v[16:31], a[52:55], v[64:67], v[16:31]
  ds_read_b64_tr_b16 v[32:33], v80 offset:30720
  ds_read_b64_tr_b16 v[36:37], v81 offset:30720
  ds_read_b64_tr_b16 v[34:35], v80 offset:31744
  ds_read_b64_tr_b16 v[38:39], v81 offset:31744
  s_waitcnt vmcnt(6) lgkmcnt(5)
  v_mfma_f32_32x32x16_bf16 a[88:103], v[40:43], v[68:71], a[88:103]
  s_waitcnt lgkmcnt(4)
  v_mfma_f32_32x32x16_bf16 v[16:31], v[44:47], v[68:71], v[16:31]
  ds_read_b64_tr_b16 v[84:85], v80 offset:32768
  ds_read_b64_tr_b16 v[86:87], v80 offset:33792
  ds_read_b64_tr_b16 v[88:89], v80 offset:34816
  ds_read_b64_tr_b16 v[90:91], v82 offset:0
  s_waitcnt vmcnt(5) lgkmcnt(5)
  v_mfma_f32_32x32x16_bf16 a[88:103], v[32:35], v[72:75], a[88:103]
  s_waitcnt lgkmcnt(4)
  v_mfma_f32_32x32x16_bf16 v[16:31], v[36:39], v[72:75], v[16:31]
  ds_read_b64_tr_b16 v[92:93], v82 offset:1024
  ds_read_b64_tr_b16 v[94:95], v82 offset:2048
  s_waitcnt vmcnt(4) lgkmcnt(4)
  v_mfma_f32_32x32x16_bf16 a[88:103], v[84:87], v[76:79], a[88:103]
  ds_read_b64_tr_b16 v[96:97], v82 offset:3072
  ds_read_b64_tr_b16 v[98:99], v82 offset:4096
  s_waitcnt vmcnt(3) lgkmcnt(4)
  v_mfma_f32_32x32x16_bf16 a[88:103], v[88:91], v[124:127], a[88:103]
  ds_read_b64_tr_b16 v[84:85], v82 offset:5120
  ds_read_b64_tr_b16 v[86:87], v82 offset:6144
  s_waitcnt vmcnt(2) lgkmcnt(4)
  v_mfma_f32_32x32x16_bf16 a[88:103], v[92:95], a[104:107], a[88:103]
  ds_read_b64_tr_b16 v[88:89], v81 offset:32768
  ds_read_b64_tr_b16 v[90:91], v81 offset:33792
  s_waitcnt vmcnt(1) lgkmcnt(4)
  v_mfma_f32_32x32x16_bf16 a[88:103], v[96:99], a[108:111], a[88:103]
  ds_read_b64_tr_b16 v[92:93], v81 offset:34816
  ds_read_b64_tr_b16 v[94:95], v83 offset:0
  s_waitcnt vmcnt(0) lgkmcnt(4)
  v_mfma_f32_32x32x16_bf16 a[88:103], v[84:87], v[48:51], a[88:103]
  ds_read_b64_tr_b16 v[96:97], v83 offset:1024
  ds_read_b64_tr_b16 v[98:99], v83 offset:2048
  s_waitcnt lgkmcnt(4)
  v_mfma_f32_32x32x16_bf16 v[16:31], v[88:91], v[76:79], v[16:31]
  ds_read_b64_tr_b16 v[84:85], v83 offset:3072
  ds_read_b64_tr_b16 v[86:87], v83 offset:4096
  s_waitcnt lgkmcnt(4)
  v_mfma_f32_32x32x16_bf16 v[16:31], v[92:95], v[124:127], v[16:31]
  s_nop 3
  ds_write_b128 v100, a[88:91] offset:0
  ds_read_b64_tr_b16 v[88:89], v83 offset:5120
  ds_read_b64_tr_b16 v[90:91], v83 offset:6144
  s_waitcnt lgkmcnt(5)
  v_mfma_f32_32x32x16_bf16 v[16:31], v[96:99], a[104:107], v[16:31]
  ds_write_b128 v101, a[92:95] offset:1024
  s_waitcnt lgkmcnt(4)
  v_mfma_f32_32x32x16_bf16 v[16:31], v[84:87], a[108:111], v[16:31]
  ds_write_b128 v102, a[96:99] offset:2048
  s_waitcnt lgkmcnt(2)
  v_mfma_f32_32x32x16_bf16 v[16:31], v[88:91], v[48:51], v[16:31]
  ds_write_b128 v103, a[100:103] offset:3072
  s_nop 10
  ds_write_b128 v104, v[16:19] offset:28672
  ds_write_b128 v105, v[20:23] offset:29696
  ds_write_b128 v106, v[24:27] offset:30720
  ds_write_b128 v107, v[28:31] offset:31744
  s_waitcnt lgkmcnt(0)
  s_barrier
  s_branch L_fin
.p2align 6
L_S_body:
  v_and_b32 v8, 31, v1
  v_lshrrev_b32 v9, 5, v1
  v_and_b32 v10, 1, v1
  s_lshr_b32 s8, s3, 1
  s_and_b32 s9, s3, 1
  v_lshlrev_b32 v4, 4, v9
  v_sub_u32_e64 v4, v8, v4
  v_mov_b32 v5, 0x3f80
  v_mov_b32 v6, 0x3f800000
  v_cmp_eq_u32 vcc, 0, v4
  v_cmp_eq_u32 s[46:47], 1, v4
  s_nop 0
  v_cndmask_b32 v7, 0, v5, vcc
  v_cndmask_b32 v7, v7, v6, s[46:47]
  v_accvgpr_write_b32 a16, v7
  v_cmp_eq_u32_e64 vcc, 2, v4
  v_cmp_eq_u32 s[46:47], 3, v4
  s_nop 0
  v_cndmask_b32 v7, 0, v5, vcc
  v_cndmask_b32 v7, v7, v6, s[46:47]
  v_accvgpr_write_b32 a17, v7
  v_cmp_eq_u32_e64 vcc, 4, v4
  v_cmp_eq_u32 s[46:47], 5, v4
  s_nop 0
  v_cndmask_b32 v7, 0, v5, vcc
  v_cndmask_b32 v7, v7, v6, s[46:47]
  v_accvgpr_write_b32 a18, v7
  v_cmp_eq_u32_e64 vcc, 6, v4
  v_cmp_eq_u32 s[46:47], 7, v4
  s_nop 0
  v_cndmask_b32 v7, 0, v5, vcc
  v_cndmask_b32 v7, v7, v6, s[46:47]
  v_accvgpr_write_b32 a19, v7
  v_cmp_eq_u32_e64 vcc, 8, v4
  v_cmp_eq_u32 s[46:47], 9, v4
  s_nop 0
  v_cndmask_b32 v7, 0, v5, vcc
  v_cndmask_b32 v7, v7, v6, s[46:47]
  v_accvgpr_write_b32 a20, v7
  v_cmp_eq_u32_e64 vcc, 10, v4
  v_cmp_eq_u32 s[46:47], 11, v4
  s_nop 0
  v_cndmask_b32 v7, 0, v5, vcc
  v_cndmask_b32 v7, v7, v6, s[46:47]
  v_accvgpr_write_b32 a21, v7
  v_cmp_eq_u32_e64 vcc, 12, v4
  v_cmp_eq_u32 s[46:47], 13, v4
  s_nop 0
  v_cndmask_b32 v7, 0, v5, vcc
  v_cndmask_b32 v7, v7, v6, s[46:47]
  v_accvgpr_write_b32 a22, v7
  v_cmp_eq_u32_e64 vcc, 14, v4
  v_cmp_eq_u32 s[46:47], 15, v4
  s_nop 0
  v_cndmask_b32 v7, 0, v5, vcc
  v_cndmask_b32 v7, v7, v6, s[46:47]
  v_accvgpr_write_b32 a23, v7
  v_bfe_u32 v42, v1, 1, 3
  v_lshrrev_b32 v43, 4, v1
  v_lshlrev_b32 v44, 4, v43
  v_lshlrev_b32 v45, 3, v42
  v_sub_u32 v44, v44, v45
  v_xor_b32_e64 v46, 1, v10
  v_mul_u32_u24 v46, 4232, v46
  v_add_u32_e64 v44, v44, v46
  s_mul_i32 s26, s8, 8448
  s_add_u32 s26, s26, 32184
  v_add_u32 v40, s26, v44
  v_and_b32 v44, 10, v1
  v_bfe_u32 v45, v1, 2, 1
  v_lshrrev_b32 v46, 3, v44
  v_lshlrev_b32 v46, 2, v46
  v_and_b32_e64 v44, 2, v44
  v_or3_b32 v44, v44, v45, v46
  v_lshlrev_b32_e64 v44, 6, v44
  v_lshl_add_u32 v44, v43, 4, v44
  v_mul_u32_u24 v46, 4640, v10
  v_add_u32_e64 v44, v44, v46
  s_mul_i32 s28, s8, 9280
  v_add_u32_e64 v41, s28, v44
  v_bfe_u32 v42, v1, 2, 3
  v_mul_u32_u24 v42, 57344, v42
  v_lshrrev_b32_e64 v44, 5, v1
  v_lshl_add_u32 v42, v44, 6, v42
  v_and_b32_e64 v44, 3, v1
  v_lshl_add_u32 v42, v44, 4, v42
  s_add_u32 s26, s70, s8
  s_lshl_b32 s15, s26, 7
  s_add_u32 s15, s15, 4194304
  s_mul_i32 s27, s9, 458752
  s_add_u32 s33, s15, s27
  s_sub_u32 s15, s15, s27
  s_add_u32 s15, s15, 1376256
  s_lshr_b32 s26, s70, 6
  s_lshl_b32 s26, s26, 1
  s_add_u32 s26, s26, s9
  s_mul_i32 s26, s26, 4352
  s_add_u32 s26, s26, 14753792
  s_lshl_b32 s27, s9, 11
  s_add_u32 s28, s28, s27
  s_mul_i32 s29, s3, 4640
  v_accvgpr_write_b32 a24, v40
  v_accvgpr_write_b32 a25, v41
  v_accvgpr_write_b32 a26, v42
  s_lshl_b32 s74, s69, 1
  s_and_b32 s74, s74, 0xfc
  s_lshl_b32 s75, s8, 1
  s_add_u32 s74, s74, s75
  s_and_b32 s75, s69, 1
  s_add_u32 s35, s74, s75
  s_lshl_b32 s74, s35, 1
  s_add_u32 s74, s74, s9
  s_mul_i32 s74, s74, 14336
  s_lshl_b32 s34, s7, 7
  s_add_u32 s74, s74, s34
  s_add_u32 s75, s74, 7168
  v_lshrrev_b32 v32, 3, v1
  v_and_b32 v33, 7, v1
  v_mul_u32_u24 v13, 896, v32
  v_lshl_add_u32 v13, v33, 4, v13
  v_lshl_add_u32 v34, v33, 4, s34
  v_accvgpr_write_b32 a27, v34
  s_mul_i32 s18, s3, 4224
  s_mov_b32 s20, s18
  s_lshl_b32 s19, s9, 2
  s_add_u32 s18, s18, s19
  s_add_u32 s18, s18, 36208
  s_waitcnt vmcnt(8)
  v_and_b32_e64 v11, 15, v1
  v_lshl_add_u32 v7, v11, 2, s18
  ds_write_b32 v7, v14 offset:16
  s_add_u32 s18, s20, 33136
  v_sub_u32 v5, s18, v3
  v_lshrrev_b32 v7, 4, v1
  v_and_b32 v4, 7, v1
  v_xor_b32 v7, v7, v4
  v_lshlrev_b32_e64 v7, 4, v7
  v_lshl_add_u32 v7, v11, 7, v7
  v_xor_b32 v2, 64, v7
  v_add_u32 v7, s20, v7
  v_add_u32 v2, s20, v2
  v_lshlrev_b32 v6, 4, v4
  v_lshl_add_u32 v6, v8, 7, v6
  s_mov_b32 s12, 0x3fb8aa3b
  s_mov_b32 s13, 0x3e22f983
  s_and_b32 s22, s2, 31
  s_mul_i32 s22, s22, 4352
  s_lshl_b32 s19, s9, 6
  s_add_u32 s22, s22, s19
  s_add_u32 s22, s22, 14942208
  s_add_u32 s25, s70, s8
  s_mul_i32 s25, s25, 4224
  s_lshl_b32 s19, s9, 11
  s_add_u32 s25, s25, s19
  s_add_u32 s25, s25, 4092
  s_cmp_eq_u32 s8, 0
  s_cselect_b32 s10, 16, 0
  s_waitcnt lgkmcnt(0)
  s_lshl_b32 s71, s71, s10
  s_and_b32 s71, s71, s14
  s_lshl_b32 s72, s72, s10
  s_and_b32 s72, s72, s14
  v_mov_b32 v126, s12
  v_mul_f32 v126, s71, v126
  v_exp_f32 v126, v126
  s_nop 0
  v_cvt_pk_bf16_f32 v126, 0, v126
  s_setprio 0
  s_waitcnt vmcnt(7)
  v_lshlrev_b32 v16, 16, v120
  s_waitcnt vmcnt(6)
  v_lshlrev_b32 v17, 16, v121
  s_waitcnt vmcnt(5)
  v_lshlrev_b32 v18, 16, v122
  s_waitcnt vmcnt(4)
  v_lshlrev_b32 v19, 16, v123
  s_waitcnt vmcnt(3)
  v_lshlrev_b32 v20, 16, v124
  s_waitcnt vmcnt(2)
  v_lshlrev_b32_e64 v21, 16, v125
  v_pk_mul_f32 v[16:17], v[16:17], v[126:127] op_sel_hi:[1,0]
  v_pk_mul_f32 v[18:19], v[18:19], v[126:127] op_sel_hi:[1,0]
  v_pk_mul_f32 v[16:17], v[16:17], s[12:13]
  v_pk_mul_f32 v[26:27], v[20:21], v[18:19] op_sel:[0,0] op_sel_hi:[1,0]
  v_pk_fma_f32 v[26:27], v[20:21], v[18:19], v[26:27] op_sel:[1,1,0] op_sel_hi:[0,1,1] neg_lo:[1,0,0]
  v_rndne_f32 v28, v17
  v_exp_f32 v30, v16
  v_sub_f32 v17, v17, v28
  v_cos_f32 v22, v17
  v_sin_f32_e64 v23, v17
  v_mul_f32 v18, 0x42800000, v16
  v_mul_f32 v19, 0x42800000, v17
  v_pk_mul_f32 v[22:23], v[22:23], v[30:31] op_sel_hi:[1,0]
  v_rndne_f32 v28, v19
  v_exp_f32 v30, v18
  v_sub_f32 v19, v19, v28
  v_cos_f32 v24, v19
  v_sin_f32_e64 v25, v19
  v_pk_mul_f32 v[36:37], v[22:23], v[22:23] op_sel:[0,0] op_sel_hi:[1,0]
  v_pk_fma_f32 v[36:37], v[22:23], v[22:23], v[36:37] op_sel:[1,1,0] op_sel_hi:[0,1,1] neg_lo:[1,0,0]
  v_pk_mul_f32 v[24:25], v[24:25], v[30:31] op_sel_hi:[1,0]
  v_pk_mul_f32 v[38:39], v[36:37], v[36:37] op_sel:[0,0] op_sel_hi:[1,0]
  v_pk_fma_f32 v[38:39], v[36:37], v[36:37], v[38:39] op_sel:[1,1,0] op_sel_hi:[0,1,1] neg_lo:[1,0,0]
  v_pk_mul_f32 v[34:35], v[38:39], v[38:39] op_sel:[0,0] op_sel_hi:[1,0]
  v_pk_fma_f32 v[34:35], v[38:39], v[38:39], v[34:35] op_sel:[1,1,0] op_sel_hi:[0,1,1] neg_lo:[1,0,0]
  v_pk_mul_f32 v[36:37], v[34:35], v[34:35] op_sel:[0,0] op_sel_hi:[1,0]
  v_pk_fma_f32 v[36:37], v[34:35], v[34:35], v[36:37] op_sel:[1,1,0] op_sel_hi:[0,1,1] neg_lo:[1,0,0]
  v_pk_mul_f32 v[38:39], v[36:37], v[34:35] op_sel:[0,0] op_sel_hi:[1,0]
  v_pk_fma_f32 v[38:39], v[36:37], v[34:35], v[38:39] op_sel:[1,1,0] op_sel_hi:[0,1,1] neg_lo:[1,0,0]
  v_pk_mul_f32 v[40:41], v[38:39], v[34:35] op_sel:[0,0] op_sel_hi:[1,0]
  v_pk_fma_f32 v[40:41], v[38:39], v[34:35], v[40:41] op_sel:[1,1,0] op_sel_hi:[0,1,1] neg_lo:[1,0,0]
  v_pk_mul_f32 v[42:43], v[40:41], v[34:35] op_sel:[0,0] op_sel_hi:[1,0]
  v_pk_fma_f32 v[42:43], v[40:41], v[34:35], v[42:43] op_sel:[1,1,0] op_sel_hi:[0,1,1] neg_lo:[1,0,0]
  v_pk_mul_f32 v[44:45], v[42:43], v[34:35] op_sel:[0,0] op_sel_hi:[1,0]
  v_pk_fma_f32 v[44:45], v[42:43], v[34:35], v[44:45] op_sel:[1,1,0] op_sel_hi:[0,1,1] neg_lo:[1,0,0]
  v_pk_mul_f32 v[46:47], v[44:45], v[34:35] op_sel:[0,0] op_sel_hi:[1,0]
  v_pk_fma_f32 v[46:47], v[44:45], v[34:35], v[46:47] op_sel:[1,1,0] op_sel_hi:[0,1,1] neg_lo:[1,0,0]
  v_cvt_pk_bf16_f32 v48, 1.0, v34
  v_cvt_pk_bf16_f32 v49, v36, v38
  v_cvt_pk_bf16_f32 v50, v40, v42
  v_cvt_pk_bf16_f32 v51, v44, v46
  s_nop 1
  v_mfma_f32_32x32x16_bf16 v[56:71], v[48:51], a[16:19], 0
  v_cvt_pk_bf16_f32 v52, 0, v35
  v_cvt_pk_bf16_f32 v53, v37, v39
  v_cvt_pk_bf16_f32 v54, v41, v43
  v_cvt_pk_bf16_f32 v55, v45, v47
  s_nop 1
  v_mfma_f32_32x32x16_bf16 v[72:87], v[52:55], a[16:19], 0
  v_mul_f32 v28, v34, v24
  v_mul_f32 v29, v34, v25
  v_fma_f32 v34, -v35, v25, v28
  v_fma_f32 v35, v35, v24, v29
  v_mul_f32 v28, v36, v24
  v_mul_f32 v29, v36, v25
  v_fma_f32 v36, -v37, v25, v28
  v_fma_f32 v37, v37, v24, v29
  v_pk_mul_f32 v[28:29], v[38:39], v[24:25] op_sel:[0,0] op_sel_hi:[1,0]
  v_pk_fma_f32 v[38:39], v[38:39], v[24:25], v[28:29] op_sel:[1,1,0] op_sel_hi:[0,1,1] neg_lo:[1,0,0]
  v_pk_mul_f32 v[28:29], v[40:41], v[24:25] op_sel:[0,0] op_sel_hi:[1,0]
  v_pk_fma_f32 v[40:41], v[40:41], v[24:25], v[28:29] op_sel:[1,1,0] op_sel_hi:[0,1,1] neg_lo:[1,0,0]
  v_pk_mul_f32 v[28:29], v[42:43], v[24:25] op_sel:[0,0] op_sel_hi:[1,0]
  v_pk_fma_f32 v[42:43], v[42:43], v[24:25], v[28:29] op_sel:[1,1,0] op_sel_hi:[0,1,1] neg_lo:[1,0,0]
  v_pk_mul_f32 v[28:29], v[44:45], v[24:25] op_sel:[0,0] op_sel_hi:[1,0]
  v_pk_fma_f32 v[44:45], v[44:45], v[24:25], v[28:29] op_sel:[1,1,0] op_sel_hi:[0,1,1] neg_lo:[1,0,0]
  v_pk_mul_f32 v[28:29], v[46:47], v[24:25] op_sel:[0,0] op_sel_hi:[1,0]
  v_pk_fma_f32 v[46:47], v[46:47], v[24:25], v[28:29] op_sel:[1,1,0] op_sel_hi:[0,1,1] neg_lo:[1,0,0]
  v_cvt_pk_bf16_f32 v48, v24, v34
  v_cvt_pk_bf16_f32 v49, v36, v38
  v_cvt_pk_bf16_f32 v50, v40, v42
  v_cvt_pk_bf16_f32 v51, v44, v46
  s_nop 1
  v_mfma_f32_32x32x16_bf16 v[56:71], v[48:51], a[20:23], v[56:71]
  v_cvt_pk_bf16_f32 v52, v25, v35
  v_cvt_pk_bf16_f32 v53, v37, v39
  v_cvt_pk_bf16_f32 v54, v41, v43
  v_cvt_pk_bf16_f32 v55, v45, v47
  s_nop 1
  v_mfma_f32_32x32x16_bf16 v[72:87], v[52:55], a[20:23], v[72:87]
  v_mul_f32 v32, v24, v24
  v_mul_f32 v33, v24, v25
  v_fma_f32 v32, -v25, v25, v32
  v_fma_f32 v33, v25, v24, v33
  v_mul_f32 v28, v34, v24
  v_mul_f32 v29, v34, v25
  v_fma_f32 v34, -v35, v25, v28
  v_fma_f32 v35, v35, v24, v29
  v_pk_mul_f32 v[28:29], v[36:37], v[24:25] op_sel:[0,0] op_sel_hi:[1,0]
  v_pk_fma_f32 v[36:37], v[36:37], v[24:25], v[28:29] op_sel:[1,1,0] op_sel_hi:[0,1,1] neg_lo:[1,0,0]
  v_pk_mul_f32 v[28:29], v[38:39], v[24:25] op_sel:[0,0] op_sel_hi:[1,0]
  v_pk_fma_f32 v[38:39], v[38:39], v[24:25], v[28:29] op_sel:[1,1,0] op_sel_hi:[0,1,1] neg_lo:[1,0,0]
  v_pk_mul_f32 v[28:29], v[40:41], v[24:25] op_sel:[0,0] op_sel_hi:[1,0]
  v_pk_fma_f32 v[40:41], v[40:41], v[24:25], v[28:29] op_sel:[1,1,0] op_sel_hi:[0,1,1] neg_lo:[1,0,0]
  v_pk_mul_f32 v[28:29], v[42:43], v[24:25] op_sel:[0,0] op_sel_hi:[1,0]
  v_pk_fma_f32 v[42:43], v[42:43], v[24:25], v[28:29] op_sel:[1,1,0] op_sel_hi:[0,1,1] neg_lo:[1,0,0]
  v_pk_mul_f32 v[28:29], v[44:45], v[24:25] op_sel:[0,0] op_sel_hi:[1,0]
  v_pk_fma_f32 v[44:45], v[44:45], v[24:25], v[28:29] op_sel:[1,1,0] op_sel_hi:[0,1,1] neg_lo:[1,0,0]
  v_pk_mul_f32 v[28:29], v[46:47], v[24:25] op_sel:[0,0] op_sel_hi:[1,0]
  v_pk_fma_f32 v[46:47], v[46:47], v[24:25], v[28:29] op_sel:[1,1,0] op_sel_hi:[0,1,1] neg_lo:[1,0,0]
  v_cvt_pk_bf16_f32 v88, v56, v57
  v_cvt_pk_bf16_f32 v89, v58, v59
  v_cvt_pk_bf16_f32 v90, v60, v61
  v_cvt_pk_bf16_f32 v91, v62, v63
  v_cvt_pk_bf16_f32 v92, v64, v65
  v_cvt_pk_bf16_f32 v93, v66, v67
  v_cvt_pk_bf16_f32 v94, v68, v69
  v_cvt_pk_bf16_f32 v95, v70, v71
  v_cvt_pk_bf16_f32 v48, v32, v34
  v_cvt_pk_bf16_f32 v49, v36, v38
  v_cvt_pk_bf16_f32 v50, v40, v42
  v_cvt_pk_bf16_f32 v51, v44, v46
  s_nop 1
  s_nop 0
  v_mfma_f32_32x32x16_bf16 v[56:71], v[48:51], a[16:19], 0
  v_cvt_pk_bf16_f32 v96, v72, v73
  v_cvt_pk_bf16_f32 v97, v74, v75
  v_cvt_pk_bf16_f32 v98, v76, v77
  v_cvt_pk_bf16_f32 v99, v78, v79
  v_cvt_pk_bf16_f32 v100, v80, v81
  v_cvt_pk_bf16_f32 v101, v82, v83
  v_cvt_pk_bf16_f32 v102, v84, v85
  v_cvt_pk_bf16_f32 v103, v86, v87
  v_cvt_pk_bf16_f32 v52, v33, v35
  v_cvt_pk_bf16_f32 v53, v37, v39
  v_cvt_pk_bf16_f32 v54, v41, v43
  v_cvt_pk_bf16_f32 v55, v45, v47
  s_nop 1
  v_mfma_f32_32x32x16_bf16 v[72:87], v[52:55], a[16:19], 0
  v_mul_f32 v28, v32, v24
  v_mul_f32_e64 v29, v32, v25
  v_fma_f32 v32, -v33, v25, v28
  v_fma_f32 v33, v33, v24, v29
  v_mul_f32 v28, v34, v24
  v_mul_f32 v29, v34, v25
  v_fma_f32 v34, -v35, v25, v28
  v_fma_f32 v35, v35, v24, v29
  v_pk_mul_f32 v[28:29], v[36:37], v[24:25] op_sel:[0,0] op_sel_hi:[1,0]
  v_pk_fma_f32 v[36:37], v[36:37], v[24:25], v[28:29] op_sel:[1,1,0] op_sel_hi:[0,1,1] neg_lo:[1,0,0]
  v_pk_mul_f32 v[28:29], v[38:39], v[24:25] op_sel:[0,0] op_sel_hi:[1,0]
  v_pk_fma_f32 v[38:39], v[38:39], v[24:25], v[28:29] op_sel:[1,1,0] op_sel_hi:[0,1,1] neg_lo:[1,0,0]
  v_pk_mul_f32 v[28:29], v[40:41], v[24:25] op_sel:[0,0] op_sel_hi:[1,0]
  v_pk_fma_f32 v[40:41], v[40:41], v[24:25], v[28:29] op_sel:[1,1,0] op_sel_hi:[0,1,1] neg_lo:[1,0,0]
  v_pk_mul_f32 v[28:29], v[42:43], v[24:25] op_sel:[0,0] op_sel_hi:[1,0]
  v_pk_fma_f32 v[42:43], v[42:43], v[24:25], v[28:29] op_sel:[1,1,0] op_sel_hi:[0,1,1] neg_lo:[1,0,0]
  v_pk_mul_f32 v[28:29], v[44:45], v[24:25] op_sel:[0,0] op_sel_hi:[1,0]
  v_pk_fma_f32 v[44:45], v[44:45], v[24:25], v[28:29] op_sel:[1,1,0] op_sel_hi:[0,1,1] neg_lo:[1,0,0]
  v_pk_mul_f32 v[28:29], v[46:47], v[24:25] op_sel:[0,0] op_sel_hi:[1,0]
  v_pk_fma_f32 v[46:47], v[46:47], v[24:25], v[28:29] op_sel:[1,1,0] op_sel_hi:[0,1,1] neg_lo:[1,0,0]
  v_cvt_pk_bf16_f32 v48, v32, v34
  v_cvt_pk_bf16_f32 v49, v36, v38
  v_cvt_pk_bf16_f32 v50, v40, v42
  v_cvt_pk_bf16_f32 v51, v44, v46
  s_nop 1
  v_mfma_f32_32x32x16_bf16 v[56:71], v[48:51], a[20:23], v[56:71]
  v_cvt_pk_bf16_f32 v52, v33, v35
  v_cvt_pk_bf16_f32 v53, v37, v39
  v_cvt_pk_bf16_f32 v54, v41, v43
  v_cvt_pk_bf16_f32 v55, v45, v47
  s_nop 1
  v_mfma_f32_32x32x16_bf16 v[72:87], v[52:55], a[20:23], v[72:87]
  v_mul_f32 v28, v24, v32
  v_mul_f32 v29, v24, v33
  v_fma_f32 v24, -v25, v33, v28
  v_fma_f32 v25, v25, v32, v29
  v_mul_f32 v32, v26, v22
  v_mul_f32 v33, v26, v23
  v_fma_f32 v32, -v27, v23, v32
  v_fma_f32 v33, v27, v22, v33
  v_pk_mul_f32 v[34:35], v[32:33], v[22:23] op_sel:[0,0] op_sel_hi:[1,0]
  v_pk_fma_f32 v[34:35], v[32:33], v[22:23], v[34:35] op_sel:[1,1,0] op_sel_hi:[0,1,1] neg_lo:[1,0,0]
  v_pk_mul_f32 v[36:37], v[34:35], v[22:23] op_sel:[0,0] op_sel_hi:[1,0]
  v_pk_fma_f32 v[36:37], v[34:35], v[22:23], v[36:37] op_sel:[1,1,0] op_sel_hi:[0,1,1] neg_lo:[1,0,0]
  v_pk_mul_f32 v[38:39], v[36:37], v[22:23] op_sel:[0,0] op_sel_hi:[1,0]
  v_pk_fma_f32 v[38:39], v[36:37], v[22:23], v[38:39] op_sel:[1,1,0] op_sel_hi:[0,1,1] neg_lo:[1,0,0]
  v_pk_mul_f32 v[40:41], v[38:39], v[22:23] op_sel:[0,0] op_sel_hi:[1,0]
  v_pk_fma_f32 v[40:41], v[38:39], v[22:23], v[40:41] op_sel:[1,1,0] op_sel_hi:[0,1,1] neg_lo:[1,0,0]
  v_pk_mul_f32 v[42:43], v[40:41], v[22:23] op_sel:[0,0] op_sel_hi:[1,0]
  v_pk_fma_f32 v[42:43], v[40:41], v[22:23], v[42:43] op_sel:[1,1,0] op_sel_hi:[0,1,1] neg_lo:[1,0,0]
  v_pk_mul_f32 v[44:45], v[42:43], v[22:23] op_sel:[0,0] op_sel_hi:[1,0]
  v_pk_fma_f32 v[44:45], v[42:43], v[22:23], v[44:45] op_sel:[1,1,0] op_sel_hi:[0,1,1] neg_lo:[1,0,0]
  v_pk_mul_f32 v[46:47], v[44:45], v[22:23] op_sel:[0,0] op_sel_hi:[1,0]
  v_pk_fma_f32 v[46:47], v[44:45], v[22:23], v[46:47] op_sel:[1,1,0] op_sel_hi:[0,1,1] neg_lo:[1,0,0]
  v_cvt_pk_bf16_f32 v104, v56, v57
  v_cvt_pk_bf16_f32 v105, v58, v59
  v_cvt_pk_bf16_f32 v106, v60, v61
  v_cvt_pk_bf16_f32 v107, v62, v63
  v_cvt_pk_bf16_f32 v108, v64, v65
  v_cvt_pk_bf16_f32 v109, v66, v67
  v_cvt_pk_bf16_f32 v110, v68, v69
  v_cvt_pk_bf16_f32 v111, v70, v71
  v_cvt_pk_bf16_f32 v48, v26, v32
  v_cvt_pk_bf16_f32 v49, v34, v36
  v_cvt_pk_bf16_f32 v50, v38, v40
  v_cvt_pk_bf16_f32 v51, v42, v44
  s_nop 1
  s_nop 0
  v_mfma_f32_32x32x16_bf16 v[56:71], v[48:51], a[16:19], 0
  v_cvt_pk_bf16_f32 v112, v72, v73
  v_cvt_pk_bf16_f32 v113, v74, v75
  v_cvt_pk_bf16_f32 v114, v76, v77
  v_cvt_pk_bf16_f32 v115, v78, v79
  v_cvt_pk_bf16_f32 v116, v80, v81
  v_cvt_pk_bf16_f32 v117, v82, v83
  v_cvt_pk_bf16_f32 v118, v84, v85
  v_cvt_pk_bf16_f32 v119, v86, v87
  v_cvt_pk_bf16_f32 v52, -v27, -v33
  v_cvt_pk_bf16_f32 v53, -v35, -v37
  v_cvt_pk_bf16_f32 v54, -v39, -v41
  v_cvt_pk_bf16_f32 v55, -v43, -v45
  s_nop 1
  v_mfma_f32_32x32x16_bf16 v[72:87], v[52:55], a[16:19], 0
  v_mov_b32 v16, v46
  v_mov_b32 v17, v47
  v_mul_f32 v28, v26, v24
  v_mul_f32_e64 v29, v26, v25
  v_fma_f32 v26, -v27, v25, v28
  v_fma_f32 v27, v27, v24, v29
  v_mul_f32 v28, v34, v24
  v_mul_f32 v29, v34, v25
  v_fma_f32 v34, -v35, v25, v28
  v_fma_f32 v35, v35, v24, v29
  v_pk_mul_f32 v[28:29], v[38:39], v[24:25] op_sel:[0,0] op_sel_hi:[1,0]
  v_pk_fma_f32 v[38:39], v[38:39], v[24:25], v[28:29] op_sel:[1,1,0] op_sel_hi:[0,1,1] neg_lo:[1,0,0]
  v_pk_mul_f32 v[28:29], v[42:43], v[24:25] op_sel:[0,0] op_sel_hi:[1,0]
  v_pk_fma_f32 v[42:43], v[42:43], v[24:25], v[28:29] op_sel:[1,1,0] op_sel_hi:[0,1,1] neg_lo:[1,0,0]
  v_pk_mul_f32 v[28:29], v[46:47], v[24:25] op_sel:[0,0] op_sel_hi:[1,0]
  v_pk_fma_f32 v[46:47], v[46:47], v[24:25], v[28:29] op_sel:[1,1,0] op_sel_hi:[0,1,1] neg_lo:[1,0,0]
  v_mov_b32 v20, v46
  v_mov_b32 v21, v47
  v_cvt_pk_bf16_f32 v48, v26, v26
  v_cvt_pk_bf16_f32 v49, v34, v38
  v_cvt_pk_bf16_f32 v50, v38, v38
  v_cvt_pk_bf16_f32 v51, v42, v46
  s_nop 1
  v_mfma_f32_32x32x16_bf16 v[56:71], v[48:51], a[20:23], v[56:71]
  v_cvt_pk_bf16_f32 v52, -v27, -v27
  v_cvt_pk_bf16_f32 v53, -v35, -v39
  v_cvt_pk_bf16_f32 v54, -v39, -v39
  v_cvt_pk_bf16_f32 v55, -v43, -v47
  s_nop 1
  v_mfma_f32_32x32x16_bf16 v[72:87], v[52:55], a[20:23], v[72:87]
  v_mul_f32 v28, v26, v24
  v_mul_f32 v29, v26, v25
  v_fma_f32 v26, -v27, v25, v28
  v_fma_f32 v27, v27, v24, v29
  v_mul_f32 v28, v38, v24
  v_mul_f32 v29, v38, v25
  v_fma_f32 v38, -v39, v25, v28
  v_fma_f32 v39, v39, v24, v29
  v_pk_mul_f32 v[28:29], v[46:47], v[24:25] op_sel:[0,0] op_sel_hi:[1,0]
  v_pk_fma_f32 v[46:47], v[46:47], v[24:25], v[28:29] op_sel:[1,1,0] op_sel_hi:[0,1,1] neg_lo:[1,0,0]
  v_cvt_pk_bf16_f32 v48, v26, v38
  v_cvt_pk_bf16_f32 v52, -v27, -v39
  v_cvt_pk_bf16_f32 v49, v46, v16
  v_cvt_pk_bf16_f32 v53, -v47, -v17
  v_pk_mul_f32 v[28:29], v[26:27], v[24:25] op_sel:[0,0] op_sel_hi:[1,0]
  v_pk_fma_f32 v[26:27], v[26:27], v[24:25], v[28:29] op_sel:[1,1,0] op_sel_hi:[0,1,1] neg_lo:[1,0,0]
  v_pk_mul_f32 v[28:29], v[38:39], v[24:25] op_sel:[0,0] op_sel_hi:[1,0]
  v_pk_fma_f32 v[38:39], v[38:39], v[24:25], v[28:29] op_sel:[1,1,0] op_sel_hi:[0,1,1] neg_lo:[1,0,0]
  v_pk_mul_f32 v[28:29], v[46:47], v[24:25] op_sel:[0,0] op_sel_hi:[1,0]
  v_pk_fma_f32 v[46:47], v[46:47], v[24:25], v[28:29] op_sel:[1,1,0] op_sel_hi:[0,1,1] neg_lo:[1,0,0]
  v_cvt_pk_bf16_f32 v50, v26, v38
  v_cvt_pk_bf16_f32 v54, -v27, -v39
  v_cvt_pk_bf16_f32 v51, v46, v20
  v_cvt_pk_bf16_f32 v55, -v47, -v21
  v_cvt_pk_bf16_f32 v56, v56, v57
  v_cvt_pk_bf16_f32 v57, v58, v59
  v_cvt_pk_bf16_f32 v58, v60, v61
  v_cvt_pk_bf16_f32 v59, v62, v63
  v_cvt_pk_bf16_f32 v60, v64, v65
  v_cvt_pk_bf16_f32 v61, v66, v67
  v_cvt_pk_bf16_f32 v62, v68, v69
  v_cvt_pk_bf16_f32 v63, v70, v71
  v_cvt_pk_bf16_f32 v72, v72, v73
  v_cvt_pk_bf16_f32 v73, v74, v75
  v_cvt_pk_bf16_f32 v74, v76, v77
  v_cvt_pk_bf16_f32 v75, v78, v79
  v_cvt_pk_bf16_f32 v76, v80, v81
  v_cvt_pk_bf16_f32 v77, v82, v83
  v_cvt_pk_bf16_f32 v78, v84, v85
  v_cvt_pk_bf16_f32 v79, v86, v87
  v_mfma_f32_16x16x32_bf16 a[0:3], v[56:59], v[88:91], 0
  v_mfma_f32_16x16x32_bf16 a[4:7], v[56:59], v[104:107], 0
  v_mfma_f32_16x16x32_bf16 a[0:3], v[60:63], v[92:95], a[0:3]
  v_mfma_f32_16x16x32_bf16 a[4:7], v[60:63], v[108:111], a[4:7]
  v_mfma_f32_16x16x32_bf16 a[0:3], v[72:75], v[96:99], a[0:3]
  v_mfma_f32_16x16x32_bf16 a[4:7], v[72:75], v[112:115], a[4:7]
  v_mfma_f32_16x16x32_bf16 a[0:3], v[76:79], v[100:103], a[0:3]
  v_mfma_f32_16x16x32_bf16 a[4:7], v[76:79], v[116:119], a[4:7]
  v_mfma_f32_32x32x16_bf16 v[56:71], v[48:51], a[16:19], 0
  v_mfma_f32_32x32x16_bf16 v[72:87], v[52:55], a[16:19], 0
  v_mul_f32 v28, v26, v24
  v_mul_f32 v29, v26, v25
  v_fma_f32 v26, -v27, v25, v28
  v_fma_f32 v27, v27, v24, v29
  v_mul_f32 v28, v46, v24
  v_mul_f32 v29, v46, v25
  v_fma_f32 v46, -v47, v25, v28
  v_fma_f32 v47, v47, v24, v29
  v_cvt_pk_bf16_f32 v48, v26, v46
  v_cvt_pk_bf16_f32 v52, -v27, -v47
  v_pk_mul_f32 v[28:29], v[26:27], v[24:25] op_sel:[0,0] op_sel_hi:[1,0]
  v_pk_fma_f32 v[26:27], v[26:27], v[24:25], v[28:29] op_sel:[1,1,0] op_sel_hi:[0,1,1] neg_lo:[1,0,0]
  v_pk_mul_f32 v[28:29], v[46:47], v[24:25] op_sel:[0,0] op_sel_hi:[1,0]
  v_pk_fma_f32 v[46:47], v[46:47], v[24:25], v[28:29] op_sel:[1,1,0] op_sel_hi:[0,1,1] neg_lo:[1,0,0]
  v_cvt_pk_bf16_f32 v49, v26, v46
  v_cvt_pk_bf16_f32 v53, -v27, -v47
  v_pk_mul_f32 v[28:29], v[26:27], v[24:25] op_sel:[0,0] op_sel_hi:[1,0]
  v_pk_fma_f32 v[26:27], v[26:27], v[24:25], v[28:29] op_sel:[1,1,0] op_sel_hi:[0,1,1] neg_lo:[1,0,0]
  v_pk_mul_f32 v[28:29], v[46:47], v[24:25] op_sel:[0,0] op_sel_hi:[1,0]
  v_pk_fma_f32 v[46:47], v[46:47], v[24:25], v[28:29] op_sel:[1,1,0] op_sel_hi:[0,1,1] neg_lo:[1,0,0]
  v_cvt_pk_bf16_f32 v50, v26, v46
  v_cvt_pk_bf16_f32 v54, -v27, -v47
  v_pk_mul_f32 v[28:29], v[26:27], v[24:25] op_sel:[0,0] op_sel_hi:[1,0]
  v_pk_fma_f32 v[26:27], v[26:27], v[24:25], v[28:29] op_sel:[1,1,0] op_sel_hi:[0,1,1] neg_lo:[1,0,0]
  v_pk_mul_f32 v[28:29], v[46:47], v[24:25] op_sel:[0,0] op_sel_hi:[1,0]
  v_pk_fma_f32 v[46:47], v[46:47], v[24:25], v[28:29] op_sel:[1,1,0] op_sel_hi:[0,1,1] neg_lo:[1,0,0]
  v_cvt_pk_bf16_f32 v51, v26, v46
  s_nop 1
  v_mfma_f32_32x32x16_bf16 v[56:71], v[48:51], a[20:23], v[56:71]
  v_cvt_pk_bf16_f32 v55, -v27, -v47
  s_nop 1
  v_mfma_f32_32x32x16_bf16 v[72:87], v[52:55], a[20:23], v[72:87]
  s_lshl_b32 s30, s9, 2
  s_sub_u32 s30, s22, s30
  s_mov_b32 s32, s8
  s_getpc_b64 s[36:37]
  v_and_b32 v16, s14, v120
  v_and_b32 v17, s14, v121
  v_and_b32 v18, s14, v122
  v_and_b32 v19, s14, v123
  v_and_b32 v20, s14, v124
  v_and_b32 v21, s14, v125
  v_pk_mul_f32 v[16:17], v[16:17], v[126:127] op_sel_hi:[1,0]
  v_pk_mul_f32 v[18:19], v[18:19], v[126:127] op_sel_hi:[1,0]
  v_pk_mul_f32 v[16:17], v[16:17], s[12:13]
  v_pk_mul_f32 v[26:27], v[20:21], v[18:19] op_sel:[0,0] op_sel_hi:[1,0]
  v_pk_fma_f32 v[26:27], v[20:21], v[18:19], v[26:27] op_sel:[1,1,0] op_sel_hi:[0,1,1] neg_lo:[1,0,0]
  v_cvt_pk_bf16_f32 v56, v56, v57
  v_cvt_pk_bf16_f32 v57, v58, v59
  v_cvt_pk_bf16_f32 v58, v60, v61
  v_cvt_pk_bf16_f32 v59, v62, v63
  v_cvt_pk_bf16_f32 v60, v64, v65
  v_cvt_pk_bf16_f32 v61, v66, v67
  v_cvt_pk_bf16_f32 v62, v68, v69
  v_cvt_pk_bf16_f32 v63, v70, v71
  v_cvt_pk_bf16_f32 v72, v72, v73
  v_cvt_pk_bf16_f32 v73, v74, v75
  v_cvt_pk_bf16_f32 v74, v76, v77
  v_cvt_pk_bf16_f32 v75, v78, v79
  v_cvt_pk_bf16_f32 v76, v80, v81
  v_cvt_pk_bf16_f32 v77, v82, v83
  v_cvt_pk_bf16_f32 v78, v84, v85
  v_cvt_pk_bf16_f32 v79, v86, v87
  v_mfma_f32_16x16x32_bf16 a[8:11], v[56:59], v[88:91], 0
  v_rndne_f32_e64 v28, v17
  v_mfma_f32_16x16x32_bf16 a[12:15], v[56:59], v[104:107], 0
  v_exp_f32_e64 v30, v16
  v_mfma_f32_16x16x32_bf16 a[8:11], v[60:63], v[92:95], a[8:11]
  v_sub_f32_e64 v17, v17, v28
  v_mfma_f32_16x16x32_bf16 a[12:15], v[60:63], v[108:111], a[12:15]
  v_cos_f32_e64 v22, v17
  v_mfma_f32_16x16x32_bf16 a[8:11], v[72:75], v[96:99], a[8:11]
  v_sin_f32_e64 v23, v17
  v_mfma_f32_16x16x32_bf16 a[12:15], v[72:75], v[112:115], a[12:15]
  v_mul_f32 v18, 0x42800000, v16
  v_mfma_f32_16x16x32_bf16 a[8:11], v[76:79], v[100:103], a[8:11]
  v_mul_f32 v19, 0x42800000, v17
  v_mfma_f32_16x16x32_bf16 a[12:15], v[76:79], v[116:119], a[12:15]
  v_pk_mul_f32 v[22:23], v[22:23], v[30:31] op_sel_hi:[1,0]
  v_rndne_f32 v28, v19
  v_exp_f32 v30, v18
  v_sub_f32 v19, v19, v28
  v_cos_f32 v24, v19
  v_sin_f32_e64 v25, v19
  v_pk_mul_f32 v[36:37], v[22:23], v[22:23] op_sel:[0,0] op_sel_hi:[1,0]
  v_pk_fma_f32 v[36:37], v[22:23], v[22:23], v[36:37] op_sel:[1,1,0] op_sel_hi:[0,1,1] neg_lo:[1,0,0]
  v_pk_mul_f32 v[24:25], v[24:25], v[30:31] op_sel_hi:[1,0]
  v_mul_f32 v38, v36, v36
  v_mul_f32 v39, v36, v37
  v_fma_f32 v38, -v37, v37, v38
  v_fma_f32 v39, v37, v36, v39
  v_mul_f32 v34, v38, v38
  v_mul_f32 v35, v38, v39
  v_fma_f32 v34, -v39, v39, v34
  v_fma_f32 v35, v39, v38, v35
  v_mul_f32 v36, v34, v34
  v_mul_f32 v37, v34, v35
  v_fma_f32 v36, -v35, v35, v36
  v_fma_f32 v37, v35, v34, v37
  v_mul_f32 v38, v36, v34
  v_mul_f32 v39, v36, v35
  v_fma_f32 v38, -v37, v35, v38
  v_fma_f32 v39, v37, v34, v39
  v_mul_f32 v40, v38, v34
  v_mul_f32 v41, v38, v35
  v_fma_f32 v40, -v39, v35, v40
  v_fma_f32 v41, v39, v34, v41
  v_mul_f32 v42, v40, v34
  v_mul_f32 v43, v40, v35
  v_fma_f32 v42, -v41, v35, v42
  v_fma_f32 v43, v41, v34, v43
  v_mul_f32 v44, v42, v34
  v_mul_f32 v45, v42, v35
  v_fma_f32 v44, -v43, v35, v44
  v_fma_f32 v45, v43, v34, v45
  v_mul_f32 v46, v44, v34
  v_mul_f32 v47, v44, v35
  v_fma_f32 v46, -v45, v35, v46
  v_fma_f32 v47, v45, v34, v47
  v_cvt_pk_bf16_f32 v48, 1.0, v34
  v_cvt_pk_bf16_f32 v49, v36, v38
  v_cvt_pk_bf16_f32 v50, v40, v42
  v_cvt_pk_bf16_f32 v51, v44, v46
  s_nop 1
  v_mfma_f32_32x32x16_bf16 v[56:71], v[48:51], a[16:19], 0
  v_cvt_pk_bf16_f32 v52, 0, v35
  v_cvt_pk_bf16_f32 v53, v37, v39
  v_cvt_pk_bf16_f32 v54, v41, v43
  v_cvt_pk_bf16_f32 v55, v45, v47
  s_nop 1
  v_mfma_f32_32x32x16_bf16 v[72:87], v[52:55], a[16:19], 0
  v_mul_f32 v28, v34, v24
  v_mul_f32 v29, v34, v25
  v_fma_f32 v34, -v35, v25, v28
  v_fma_f32 v35, v35, v24, v29
  v_mul_f32 v28, v36, v24
  v_mul_f32 v29, v36, v25
  v_fma_f32 v36, -v37, v25, v28
  v_fma_f32 v37, v37, v24, v29
  v_mul_f32 v28, v38, v24
  v_mul_f32 v29, v38, v25
  v_fma_f32 v38, -v39, v25, v28
  v_fma_f32 v39, v39, v24, v29
  v_mul_f32 v28, v40, v24
  v_mul_f32 v29, v40, v25
  v_fma_f32 v40, -v41, v25, v28
  v_fma_f32 v41, v41, v24, v29
  v_mul_f32 v28, v42, v24
  v_mul_f32 v29, v42, v25
  v_fma_f32 v42, -v43, v25, v28
  v_fma_f32 v43, v43, v24, v29
  v_mul_f32 v28, v44, v24
  v_mul_f32 v29, v44, v25
  v_fma_f32 v44, -v45, v25, v28
  v_fma_f32 v45, v45, v24, v29
  v_mul_f32 v28, v46, v24
  v_mul_f32 v29, v46, v25
  v_fma_f32 v46, -v47, v25, v28
  v_fma_f32 v47, v47, v24, v29
  v_cvt_pk_bf16_f32 v48, v24, v34
  v_cvt_pk_bf16_f32 v49, v36, v38
  v_cvt_pk_bf16_f32 v50, v40, v42
  v_cvt_pk_bf16_f32 v51, v44, v46
  s_nop 1
  v_mfma_f32_32x32x16_bf16 v[56:71], v[48:51], a[20:23], v[56:71]
  v_cvt_pk_bf16_f32 v52, v25, v35
  v_cvt_pk_bf16_f32 v53, v37, v39
  v_cvt_pk_bf16_f32 v54, v41, v43
  v_cvt_pk_bf16_f32 v55, v45, v47
  s_nop 1
  v_mfma_f32_32x32x16_bf16 v[72:87], v[52:55], a[20:23], v[72:87]
  v_mul_f32 v32, v24, v24
  v_mul_f32 v33, v24, v25
  v_fma_f32 v32, -v25, v25, v32
  v_fma_f32 v33, v25, v24, v33
  v_mul_f32 v28, v34, v24
  v_mul_f32 v29, v34, v25
  v_fma_f32 v34, -v35, v25, v28
  v_fma_f32 v35, v35, v24, v29
  v_mul_f32 v28, v36, v24
  v_mul_f32 v29, v36, v25
  v_fma_f32 v36, -v37, v25, v28
  v_fma_f32 v37, v37, v24, v29
  v_mul_f32 v28, v38, v24
  v_mul_f32 v29, v38, v25
  v_fma_f32 v38, -v39, v25, v28
  v_fma_f32 v39, v39, v24, v29
  v_mul_f32 v28, v40, v24
  v_mul_f32 v29, v40, v25
  v_fma_f32 v40, -v41, v25, v28
  v_fma_f32 v41, v41, v24, v29
  v_mul_f32 v28, v42, v24
  v_mul_f32 v29, v42, v25
  v_fma_f32 v42, -v43, v25, v28
  v_fma_f32 v43, v43, v24, v29
  v_mul_f32 v28, v44, v24
  v_mul_f32 v29, v44, v25
  v_fma_f32 v44, -v45, v25, v28
  v_fma_f32 v45, v45, v24, v29
  v_mul_f32 v28, v46, v24
  v_mul_f32 v29, v46, v25
  v_fma_f32 v46, -v47, v25, v28
  v_fma_f32 v47, v47, v24, v29
  v_cvt_pk_bf16_f32 v88, v56, v57
  v_cvt_pk_bf16_f32 v89, v58, v59
  v_cvt_pk_bf16_f32 v90, v60, v61
  v_cvt_pk_bf16_f32 v91, v62, v63
  v_cvt_pk_bf16_f32 v92, v64, v65
  v_cvt_pk_bf16_f32 v93, v66, v67
  v_cvt_pk_bf16_f32 v94, v68, v69
  v_cvt_pk_bf16_f32 v95, v70, v71
  v_cvt_pk_bf16_f32 v48, v32, v34
  v_cvt_pk_bf16_f32 v49, v36, v38
  v_cvt_pk_bf16_f32 v50, v40, v42
  v_cvt_pk_bf16_f32 v51, v44, v46
  s_nop 1
  s_nop 0
  v_mfma_f32_32x32x16_bf16 v[56:71], v[48:51], a[16:19], 0
  v_cvt_pk_bf16_f32 v96, v72, v73
  v_cvt_pk_bf16_f32 v97, v74, v75
  v_cvt_pk_bf16_f32 v98, v76, v77
  v_cvt_pk_bf16_f32 v99, v78, v79
  v_cvt_pk_bf16_f32 v100, v80, v81
  v_cvt_pk_bf16_f32 v101, v82, v83
  v_cvt_pk_bf16_f32 v102, v84, v85
  v_cvt_pk_bf16_f32 v103, v86, v87
  v_cvt_pk_bf16_f32 v52, v33, v35
  v_cvt_pk_bf16_f32 v53, v37, v39
  v_cvt_pk_bf16_f32 v54, v41, v43
  v_cvt_pk_bf16_f32 v55, v45, v47
  s_nop 1
  v_mfma_f32_32x32x16_bf16 v[72:87], v[52:55], a[16:19], 0
  v_mul_f32 v28, v32, v24
  v_mul_f32_e64 v29, v32, v25
  v_fma_f32 v32, -v33, v25, v28
  v_fma_f32 v33, v33, v24, v29
  v_mul_f32 v28, v34, v24
  v_mul_f32 v29, v34, v25
  v_fma_f32 v34, -v35, v25, v28
  v_fma_f32 v35, v35, v24, v29
  v_mul_f32 v28, v36, v24
  v_mul_f32 v29, v36, v25
  v_fma_f32 v36, -v37, v25, v28
  v_fma_f32 v37, v37, v24, v29
  v_mul_f32 v28, v38, v24
  v_mul_f32 v29, v38, v25
  v_fma_f32 v38, -v39, v25, v28
  v_fma_f32 v39, v39, v24, v29
  v_mul_f32 v28, v40, v24
  v_mul_f32 v29, v40, v25
  v_fma_f32 v40, -v41, v25, v28
  v_fma_f32 v41, v41, v24, v29
  v_mul_f32 v28, v42, v24
  v_mul_f32 v29, v42, v25
  v_fma_f32 v42, -v43, v25, v28
  v_fma_f32 v43, v43, v24, v29
  v_mul_f32 v28, v44, v24
  v_mul_f32 v29, v44, v25
  v_fma_f32 v44, -v45, v25, v28
  v_fma_f32 v45, v45, v24, v29
  v_mul_f32 v28, v46, v24
  v_mul_f32 v29, v46, v25
  v_fma_f32 v46, -v47, v25, v28
  v_fma_f32 v47, v47, v24, v29
  v_cvt_pk_bf16_f32 v48, v32, v34
  v_cvt_pk_bf16_f32 v49, v36, v38
  v_cvt_pk_bf16_f32 v50, v40, v42
  v_cvt_pk_bf16_f32 v51, v44, v46
  s_nop 1
  v_mfma_f32_32x32x16_bf16 v[56:71], v[48:51], a[20:23], v[56:71]
  v_cvt_pk_bf16_f32 v52, v33, v35
  v_cvt_pk_bf16_f32 v53, v37, v39
  v_cvt_pk_bf16_f32 v54, v41, v43
  v_cvt_pk_bf16_f32 v55, v45, v47
  s_nop 1
  v_mfma_f32_32x32x16_bf16 v[72:87], v[52:55], a[20:23], v[72:87]
  v_mul_f32 v28, v24, v32
  v_mul_f32 v29, v24, v33
  v_fma_f32 v24, -v25, v33, v28
  v_fma_f32 v25, v25, v32, v29
  v_mul_f32 v32, v26, v22
  v_mul_f32 v33, v26, v23
  v_fma_f32 v32, -v27, v23, v32
  v_fma_f32 v33, v27, v22, v33
  v_mul_f32 v34, v32, v22
  v_mul_f32 v35, v32, v23
  v_fma_f32 v34, -v33, v23, v34
  v_fma_f32 v35, v33, v22, v35
  v_mul_f32 v36, v34, v22
  v_mul_f32 v37, v34, v23
  v_fma_f32 v36, -v35, v23, v36
  v_fma_f32 v37, v35, v22, v37
  v_mul_f32 v38, v36, v22
  v_mul_f32 v39, v36, v23
  v_fma_f32 v38, -v37, v23, v38
  v_fma_f32 v39, v37, v22, v39
  v_mul_f32 v40, v38, v22
  v_mul_f32 v41, v38, v23
  v_fma_f32 v40, -v39, v23, v40
  v_fma_f32 v41, v39, v22, v41
  v_mul_f32 v42, v40, v22
  v_mul_f32 v43, v40, v23
  v_fma_f32 v42, -v41, v23, v42
  v_fma_f32 v43, v41, v22, v43
  v_mul_f32 v44, v42, v22
  v_mul_f32 v45, v42, v23
  v_fma_f32 v44, -v43, v23, v44
  v_fma_f32 v45, v43, v22, v45
  v_mul_f32 v46, v44, v22
  v_mul_f32 v47, v44, v23
  v_fma_f32 v46, -v45, v23, v46
  v_fma_f32 v47, v45, v22, v47
  v_cvt_pk_bf16_f32 v104, v56, v57
  v_cvt_pk_bf16_f32 v105, v58, v59
  v_cvt_pk_bf16_f32 v106, v60, v61
  v_cvt_pk_bf16_f32 v107, v62, v63
  v_cvt_pk_bf16_f32 v108, v64, v65
  v_cvt_pk_bf16_f32 v109, v66, v67
  v_cvt_pk_bf16_f32 v110, v68, v69
  v_cvt_pk_bf16_f32 v111, v70, v71
  v_cvt_pk_bf16_f32 v48, v26, v32
  v_cvt_pk_bf16_f32 v49, v34, v36
  v_cvt_pk_bf16_f32 v50, v38, v40
  v_cvt_pk_bf16_f32 v51, v42, v44
  s_nop 1
  s_nop 0
  v_mfma_f32_32x32x16_bf16 v[56:71], v[48:51], a[16:19], 0
  v_cvt_pk_bf16_f32 v112, v72, v73
  v_cvt_pk_bf16_f32 v113, v74, v75
  v_cvt_pk_bf16_f32 v114, v76, v77
  v_cvt_pk_bf16_f32 v115, v78, v79
  v_cvt_pk_bf16_f32 v116, v80, v81
  v_cvt_pk_bf16_f32 v117, v82, v83
  v_cvt_pk_bf16_f32 v118, v84, v85
  v_cvt_pk_bf16_f32 v119, v86, v87
  v_cvt_pk_bf16_f32 v52, -v27, -v33
  v_cvt_pk_bf16_f32 v53, -v35, -v37
  v_cvt_pk_bf16_f32 v54, -v39, -v41
  v_cvt_pk_bf16_f32 v55, -v43, -v45
  s_nop 1
  v_mfma_f32_32x32x16_bf16 v[72:87], v[52:55], a[16:19], 0
  v_mov_b32 v16, v46
  v_mov_b32 v17, v47
  v_mul_f32 v28, v26, v24
  v_mul_f32_e64 v29, v26, v25
  v_fma_f32 v26, -v27, v25, v28
  v_fma_f32 v27, v27, v24, v29
  v_mul_f32 v28, v34, v24
  v_mul_f32 v29, v34, v25
  v_fma_f32 v34, -v35, v25, v28
  v_fma_f32 v35, v35, v24, v29
  v_mul_f32 v28, v38, v24
  v_mul_f32 v29, v38, v25
  v_fma_f32 v38, -v39, v25, v28
  v_fma_f32 v39, v39, v24, v29
  v_mul_f32 v28, v42, v24
  v_mul_f32 v29, v42, v25
  v_fma_f32 v42, -v43, v25, v28
  v_fma_f32 v43, v43, v24, v29
  v_mul_f32 v28, v46, v24
  v_mul_f32 v29, v46, v25
  v_fma_f32 v46, -v47, v25, v28
  v_fma_f32 v47, v47, v24, v29
  v_mov_b32 v20, v46
  v_mov_b32 v21, v47
  v_cvt_pk_bf16_f32 v48, v26, v26
  v_cvt_pk_bf16_f32 v49, v34, v38
  v_cvt_pk_bf16_f32 v50, v38, v38
  v_cvt_pk_bf16_f32 v51, v42, v46
  s_nop 1
  v_mfma_f32_32x32x16_bf16 v[56:71], v[48:51], a[20:23], v[56:71]
  v_cvt_pk_bf16_f32 v52, -v27, -v27
  v_cvt_pk_bf16_f32 v53, -v35, -v39
  v_cvt_pk_bf16_f32 v54, -v39, -v39
  v_cvt_pk_bf16_f32 v55, -v43, -v47
  s_nop 1
  v_mfma_f32_32x32x16_bf16 v[72:87], v[52:55], a[20:23], v[72:87]
  v_mul_f32 v28, v26, v24
  v_mul_f32 v29, v26, v25
  v_fma_f32 v26, -v27, v25, v28
  v_fma_f32 v27, v27, v24, v29
  v_mul_f32 v28, v38, v24
  v_mul_f32 v29, v38, v25
  v_fma_f32 v38, -v39, v25, v28
  v_fma_f32 v39, v39, v24, v29
  v_mul_f32 v28, v46, v24
  v_mul_f32 v29, v46, v25
  v_fma_f32 v46, -v47, v25, v28
  v_fma_f32 v47, v47, v24, v29
  v_cvt_pk_bf16_f32 v48, v26, v38
  v_cvt_pk_bf16_f32 v52, -v27, -v39
  v_cvt_pk_bf16_f32 v49, v46, v16
  v_cvt_pk_bf16_f32 v53, -v47, -v17
  v_mul_f32 v28, v26, v24
  v_mul_f32 v29, v26, v25
  v_fma_f32 v26, -v27, v25, v28
  v_fma_f32 v27, v27, v24, v29
  v_mul_f32 v28, v38, v24
  v_mul_f32 v29, v38, v25
  v_fma_f32 v38, -v39, v25, v28
  v_fma_f32 v39, v39, v24, v29
  v_mul_f32 v28, v46, v24
  v_mul_f32 v29, v46, v25
  v_fma_f32 v46, -v47, v25, v28
  v_fma_f32 v47, v47, v24, v29
  v_cvt_pk_bf16_f32 v50, v26, v38
  v_cvt_pk_bf16_f32 v54, -v27, -v39
  v_cvt_pk_bf16_f32 v51, v46, v20
  v_cvt_pk_bf16_f32 v55, -v47, -v21
  v_cvt_pk_bf16_f32 v56, v56, v57
  v_cvt_pk_bf16_f32 v57, v58, v59
  v_cvt_pk_bf16_f32 v58, v60, v61
  v_cvt_pk_bf16_f32 v59, v62, v63
  v_cvt_pk_bf16_f32 v60, v64, v65
  v_cvt_pk_bf16_f32 v61, v66, v67
  v_cvt_pk_bf16_f32 v62, v68, v69
  v_cvt_pk_bf16_f32 v63, v70, v71
  s_cmp_lg_u32 s32, 0
  s_cbranch_scc1 L_ua0
  s_buffer_load_dwordx16 s[76:91], s[48:51], s22 glc
  s_buffer_load_dword s31, s[48:51], s30 glc
L_ua0:
  v_cvt_pk_bf16_f32 v72, v72, v73
  v_cvt_pk_bf16_f32 v73, v74, v75
  v_cvt_pk_bf16_f32 v74, v76, v77
  v_cvt_pk_bf16_f32 v75, v78, v79
  v_cvt_pk_bf16_f32 v76, v80, v81
  v_cvt_pk_bf16_f32 v77, v82, v83
  v_cvt_pk_bf16_f32 v78, v84, v85
  v_cvt_pk_bf16_f32 v79, v86, v87
  v_mfma_f32_16x16x32_bf16 a[0:3], v[56:59], v[88:91], a[0:3]
  v_mfma_f32_16x16x32_bf16 a[4:7], v[56:59], v[104:107], a[4:7]
  v_mfma_f32_16x16x32_bf16 a[0:3], v[60:63], v[92:95], a[0:3]
  v_mfma_f32_16x16x32_bf16 a[4:7], v[60:63], v[108:111], a[4:7]
  v_mfma_f32_16x16x32_bf16 a[0:3], v[72:75], v[96:99], a[0:3]
  v_mfma_f32_16x16x32_bf16 a[4:7], v[72:75], v[112:115], a[4:7]
  v_mfma_f32_16x16x32_bf16 a[0:3], v[76:79], v[100:103], a[0:3]
  v_mfma_f32_16x16x32_bf16 a[4:7], v[76:79], v[116:119], a[4:7]
  v_mfma_f32_32x32x16_bf16 v[56:71], v[48:51], a[16:19], 0
  v_mfma_f32_32x32x16_bf16 v[72:87], v[52:55], a[16:19], 0
  v_mul_f32 v28, v26, v24
  v_mul_f32 v29, v26, v25
  v_fma_f32 v26, -v27, v25, v28
  v_fma_f32 v27, v27, v24, v29
  v_mul_f32 v28, v46, v24
  v_mul_f32 v29, v46, v25
  v_fma_f32 v46, -v47, v25, v28
  v_fma_f32 v47, v47, v24, v29
  v_cvt_pk_bf16_f32 v48, v26, v46
  v_cvt_pk_bf16_f32 v52, -v27, -v47
  v_mul_f32 v28, v26, v24
  v_mul_f32 v29, v26, v25
  v_fma_f32 v26, -v27, v25, v28
  v_fma_f32 v27, v27, v24, v29
  v_mul_f32 v28, v46, v24
  v_mul_f32 v29, v46, v25
  v_fma_f32 v46, -v47, v25, v28
  v_fma_f32 v47, v47, v24, v29
  v_cvt_pk_bf16_f32 v49, v26, v46
  v_cvt_pk_bf16_f32 v53, -v27, -v47
  v_mul_f32 v28, v26, v24
  v_mul_f32 v29, v26, v25
  v_fma_f32 v26, -v27, v25, v28
  v_fma_f32 v27, v27, v24, v29
  v_mul_f32 v28, v46, v24
  v_mul_f32 v29, v46, v25
  v_fma_f32 v46, -v47, v25, v28
  v_fma_f32 v47, v47, v24, v29
  v_cvt_pk_bf16_f32 v50, v26, v46
  v_cvt_pk_bf16_f32 v54, -v27, -v47
  v_mul_f32 v28, v26, v24
  v_mul_f32 v29, v26, v25
  v_fma_f32 v26, -v27, v25, v28
  v_fma_f32 v27, v27, v24, v29
  v_mul_f32 v28, v46, v24
  v_mul_f32 v29, v46, v25
  v_fma_f32 v46, -v47, v25, v28
  v_fma_f32 v47, v47, v24, v29
  v_cvt_pk_bf16_f32 v51, v26, v46
  s_nop 1
  v_mfma_f32_32x32x16_bf16 v[56:71], v[48:51], a[20:23], v[56:71]
  v_cvt_pk_bf16_f32 v55, -v27, -v47
  s_nop 1
  v_mfma_f32_32x32x16_bf16 v[72:87], v[52:55], a[20:23], v[72:87]
  ds_read_b32 v4, v14 offset:49064
  s_waitcnt lgkmcnt(0)
  v_cmp_gt_u32 vcc, 1, v4
  s_nop 0
  s_cbranch_vccz COK_46
  s_mov_b32 s66, 0x2000000
CLP_47:
  s_sleep 2
  ds_read_b32 v4, v14 offset:49064
  s_waitcnt lgkmcnt(0)
  v_cmp_gt_u32_e64 vcc, 1, v4
  s_sub_u32 s66, s66, 1
  s_cbranch_scc1 COK_46
  s_cbranch_vccnz CLP_47
COK_46:
  ds_read_b32 v12, v14 offset:49084
  s_nop 1
  v_cvt_pk_bf16_f32 v56, v56, v57
  v_cvt_pk_bf16_f32 v57, v58, v59
  v_cvt_pk_bf16_f32 v58, v60, v61
  v_cvt_pk_bf16_f32 v59, v62, v63
  v_cvt_pk_bf16_f32 v60, v64, v65
  v_cvt_pk_bf16_f32 v61, v66, v67
  v_cvt_pk_bf16_f32 v62, v68, v69
  v_cvt_pk_bf16_f32 v63, v70, v71
  v_cvt_pk_bf16_f32 v72, v72, v73
  v_cvt_pk_bf16_f32 v73, v74, v75
  v_cvt_pk_bf16_f32 v74, v76, v77
  v_cvt_pk_bf16_f32 v75, v78, v79
  v_cvt_pk_bf16_f32 v76, v80, v81
  v_cvt_pk_bf16_f32 v77, v82, v83
  v_cvt_pk_bf16_f32 v78, v84, v85
  v_cvt_pk_bf16_f32 v79, v86, v87
  v_mfma_f32_16x16x32_bf16 a[8:11], v[56:59], v[88:91], a[8:11]
  v_mfma_f32_16x16x32_bf16 a[12:15], v[56:59], v[104:107], a[12:15]
  v_mfma_f32_16x16x32_bf16 a[8:11], v[60:63], v[92:95], a[8:11]
  v_mfma_f32_16x16x32_bf16 a[12:15], v[60:63], v[108:111], a[12:15]
  v_mfma_f32_16x16x32_bf16 a[8:11], v[72:75], v[96:99], a[8:11]
  v_mfma_f32_16x16x32_bf16 a[12:15], v[72:75], v[112:115], a[12:15]
  v_mfma_f32_16x16x32_bf16 a[8:11], v[76:79], v[100:103], a[8:11]
  v_mfma_f32_16x16x32_bf16 a[12:15], v[76:79], v[116:119], a[12:15]
  ds_read_b32 v4, v14 offset:49040
  s_waitcnt lgkmcnt(1)
  v_readfirstlane_b32 s64, v12
  v_readfirstlane_b32 s65, v12
  s_nop 0
  s_waitcnt lgkmcnt(0)
  s_cmp_lg_u32 s32, 0
  s_cbranch_scc1 L_ut0
  v_cmp_gt_u32 vcc, 4, v4
  s_xor_b64 s[76:77], s[76:77], s[64:65]
  s_xor_b64 s[78:79], s[78:79], s[64:65]
  s_xor_b64 s[80:81], s[80:81], s[64:65]
  s_xor_b64 s[82:83], s[82:83], s[64:65]
  s_xor_b64 s[84:85], s[84:85], s[64:65]
  s_xor_b64 s[86:87], s[86:87], s[64:65]
  s_xor_b64 s[88:89], s[88:89], s[64:65]
  s_xor_b64 s[90:91], s[90:91], s[64:65]
  s_xor_b32 s31, s31, s64
  s_or_b32 s76, s76, s31
  s_or_b64 s[76:77], s[76:77], s[78:79]
  s_or_b64 s[76:77], s[76:77], s[80:81]
  s_or_b64 s[76:77], s[76:77], s[82:83]
  s_or_b64 s[76:77], s[76:77], s[84:85]
  s_or_b64 s[76:77], s[76:77], s[86:87]
  s_or_b64 s[76:77], s[76:77], s[88:89]
  s_or_b64 s[76:77], s[76:77], s[90:91]
  s_cbranch_scc1 L_ut0
  s_cbranch_vccnz L_ut0
  s_setprio 3
  s_add_u32 m0, s28, 448
  s_add_u32 s24, s25, 0
  buffer_load_dwordx4 v3, s[48:51], s24 offen offset:0 sc1 lds
  buffer_load_dwordx4 v3, s[48:51], s24 offen offset:1024 sc1 lds
  s_add_u32 m0, s28, 5088
  s_add_u32 s24, s25, 4
  buffer_load_dwordx4 v3, s[48:51], s24 offen offset:0 sc1 lds
  buffer_load_dwordx4 v3, s[48:51], s24 offen offset:1024 sc1 lds
  s_add_u32 m0, s28, 9728
  s_add_u32 s24, s25, 4224
  buffer_load_dwordx4 v3, s[48:51], s24 offen offset:0 sc1 lds
  buffer_load_dwordx4 v3, s[48:51], s24 offen offset:1024 sc1 lds
  s_add_u32 m0, s28, 14368
  s_add_u32 s24, s25, 4228
  buffer_load_dwordx4 v3, s[48:51], s24 offen offset:0 sc1 lds
  buffer_load_dwordx4 v3, s[48:51], s24 offen offset:1024 sc1 lds
  s_mov_b32 exec_lo, 0x0fffffff
  s_mov_b32 exec_hi, 0
  s_add_u32 m0, s29, 0
  s_nop 0
  buffer_load_dwordx4 v3, s[48:51], s50 offen lds
  s_add_u32 m0, s29, 9280
  s_nop 0
  buffer_load_dwordx4 v3, s[48:51], s50 offen lds
  s_lshl_b32 m0, s3, 2
  s_add_u32 m0, m0, 28832
  s_mov_b64 exec, 1
  global_load_lds_dword v14, s[36:37]
  s_mov_b64 exec, -1
  s_setprio 0
  s_mov_b32 s32, 1
L_ut0:
  s_mul_i32 s20, s8, 8448
  v_lshlrev_b32 v20, 5, v9
  v_xor_b32 v16, v20, v6
  v_xor_b32 v17, 16, v16
  v_lshlrev_b32 v20, 4, v9
  v_xor_b32 v18, 64, v6
  v_xor_b32_e64 v18, v20, v18
  v_xor_b32 v19, 96, v6
  v_lshl_add_u32 v19, v9, 3, v19
  v_xor_b32 v20, 16, v19
  v_add_u32 v16, s20, v16
  v_add_u32 v17, s20, v17
  v_add_u32 v18, s20, v18
  v_add_u32 v19, s20, v19
  v_add_u32 v20, s20, v20
  ds_write_b128 v7, a[0:3] offset:32128
  ds_write_b128 v7, a[4:7] offset:34176
  ds_write_b128 v2, a[8:11] offset:32128
  ds_write_b128 v2, a[12:15] offset:34176
  s_mov_b64 exec, 1
  ds_add_u32 v14, v15 offset:49044
  s_mov_b64 exec, -1
  ds_read_b32 v4, v14 offset:49044
  s_waitcnt lgkmcnt(0)
  v_cmp_gt_u32 vcc, 4, v4
  s_nop 0
  s_cbranch_vccz COK_49
  s_mov_b32 s66, 0x2000000
CLP_50:
  ds_read_b32 v4, v14 offset:49044
  s_waitcnt lgkmcnt(0)
  v_cmp_gt_u32_e64 vcc, 4, v4
  s_sub_u32 s66, s66, 1
  s_cbranch_scc1 COK_49
  s_cbranch_vccnz CLP_50
COK_49:
  s_cmp_lg_u32 s32, 0
  s_cbranch_scc1 L_ua2
  s_buffer_load_dwordx16 s[76:91], s[48:51], s22 glc
  s_buffer_load_dword s31, s[48:51], s30 glc
L_ua2:
  ds_read_b128 v[32:35], v16 offset:32128
  ds_read_b128 v[36:39], v17 offset:32128
  ds_read_b128 v[40:43], v18 offset:32128
  ds_read_b64 v[44:45], v19 offset:32128
  ds_read_b64 v[46:47], v20 offset:32128
  ds_read_b128 v[48:51], v16 offset:36352
  ds_read_b128 v[52:55], v17 offset:36352
  ds_read_b128 v[56:59], v18 offset:36352
  ds_read_b64 v[60:61], v19 offset:36352
  ds_read_b64 v[62:63], v20 offset:36352
  s_mov_b64 exec, 1
  ds_add_u32 v14, v15 offset:49048
  s_mov_b64 exec, -1
  s_waitcnt lgkmcnt(5)
  v_add_f32 v32, v32, v48
  v_add_f32 v33, v33, v49
  v_add_f32 v34, v34, v50
  v_add_f32 v35, v35, v51
  s_waitcnt lgkmcnt(4)
  v_add_f32 v36, v36, v52
  v_add_f32 v37, v37, v53
  v_add_f32 v38, v38, v54
  v_add_f32 v39, v39, v55
  s_waitcnt lgkmcnt(3)
  v_add_f32 v40, v40, v56
  ds_read_b32 v4, v14 offset:49048
  v_add_f32 v41, v41, v57
  v_add_f32 v42, v42, v58
  v_add_f32 v43, v43, v59
  s_waitcnt lgkmcnt(3)
  v_add_f32 v44, v44, v60
  v_add_f32 v45, v45, v61
  s_waitcnt lgkmcnt(2)
  v_add_f32 v46, v46, v62
  v_add_f32 v47, v47, v63
  s_waitcnt lgkmcnt(0)
  v_cmp_gt_u32_e64 vcc, 4, v4
  s_nop 0
  s_cbranch_vccz COK_52
  s_mov_b32 s66, 0x2000000
CLP_53:
  ds_read_b32 v4, v14 offset:49048
  s_waitcnt lgkmcnt(0)
  v_cmp_gt_u32 vcc, 4, v4
  s_sub_u32 s66, s66, 1
  s_cbranch_scc1 COK_52
  s_cbranch_vccnz CLP_53
COK_52:
  ds_read_b32 v4, v14 offset:49040
  s_waitcnt lgkmcnt(0)
  s_cmp_lg_u32 s32, 0
  s_cbranch_scc1 L_ut2
  v_cmp_gt_u32_e64 vcc, 4, v4
  s_xor_b64 s[76:77], s[76:77], s[64:65]
  s_xor_b64 s[78:79], s[78:79], s[64:65]
  s_xor_b64 s[80:81], s[80:81], s[64:65]
  s_xor_b64 s[82:83], s[82:83], s[64:65]
  s_xor_b64 s[84:85], s[84:85], s[64:65]
  s_xor_b64 s[86:87], s[86:87], s[64:65]
  s_xor_b64 s[88:89], s[88:89], s[64:65]
  s_xor_b64 s[90:91], s[90:91], s[64:65]
  s_xor_b32 s31, s31, s64
  s_or_b32 s76, s76, s31
  s_or_b64 s[76:77], s[76:77], s[78:79]
  s_or_b64 s[76:77], s[76:77], s[80:81]
  s_or_b64 s[76:77], s[76:77], s[82:83]
  s_or_b64 s[76:77], s[76:77], s[84:85]
  s_or_b64 s[76:77], s[76:77], s[86:87]
  s_or_b64 s[76:77], s[76:77], s[88:89]
  s_or_b64 s[76:77], s[76:77], s[90:91]
  s_cbranch_scc1 L_ut2
  s_cbranch_vccnz L_ut2
  s_setprio 3
  s_add_u32 m0, s28, 448
  s_add_u32 s24, s25, 0
  buffer_load_dwordx4 v3, s[48:51], s24 offen offset:0 sc1 lds
  buffer_load_dwordx4 v3, s[48:51], s24 offen offset:1024 sc1 lds
  s_add_u32 m0, s28, 5088
  s_add_u32 s24, s25, 4
  buffer_load_dwordx4 v3, s[48:51], s24 offen offset:0 sc1 lds
  buffer_load_dwordx4 v3, s[48:51], s24 offen offset:1024 sc1 lds
  s_add_u32 m0, s28, 9728
  s_add_u32 s24, s25, 4224
  buffer_load_dwordx4 v3, s[48:51], s24 offen offset:0 sc1 lds
  buffer_load_dwordx4 v3, s[48:51], s24 offen offset:1024 sc1 lds
  s_add_u32 m0, s28, 14368
  s_add_u32 s24, s25, 4228
  buffer_load_dwordx4 v3, s[48:51], s24 offen offset:0 sc1 lds
  buffer_load_dwordx4 v3, s[48:51], s24 offen offset:1024 sc1 lds
  s_mov_b32 exec_lo, 0x0fffffff
  s_mov_b32 exec_hi, 0
  s_add_u32 m0, s29, 0
  s_nop 0
  buffer_load_dwordx4 v3, s[48:51], s50 offen lds
  s_add_u32 m0, s29, 9280
  s_nop 0
  buffer_load_dwordx4 v3, s[48:51], s50 offen lds
  s_lshl_b32 m0, s3, 2
  s_add_u32 m0, m0, 28832
  s_mov_b64 exec, 1
  global_load_lds_dword v14, s[36:37]
  s_mov_b64 exec, -1
  s_setprio 0
  s_mov_b32 s32, 1
L_ut2:
  v_cmp_eq_u32 vcc, 1, v10
  s_nop 1
  v_cndmask_b32 v84, v44, v45, vcc
  v_cndmask_b32_e64 v85, v46, v47, vcc
  s_cmp_eq_u32 s9, 0
  s_cbranch_scc0 L_kb1
  v_cvt_pk_bf16_f32 v64, v39, v38
  v_cvt_pk_bf16_f32 v65, v37, v36
  v_cvt_pk_bf16_f32 v66, v35, v34
  v_cvt_pk_bf16_f32 v67, v33, v32
  ds_write_b128 v5, v[64:67] offset:3072
  v_cvt_pk_bf16_f32 v68, v42, v42
  v_cvt_pk_bf16_f32 v69, v41, v41
  v_cvt_pk_bf16_f32 v70, v41, v40
  v_cvt_pk_bf16_f32 v71, v40, v40
  ds_write_b128 v5, v[68:71] offset:2048
  v_cvt_pk_bf16_f32 v72, v45, v45
  v_cvt_pk_bf16_f32 v73, v45, v84
  v_cvt_pk_bf16_f32 v74, v44, v44
  v_cvt_pk_bf16_f32 v75, v44, v44
  ds_write_b128 v5, v[72:75] offset:1024
  v_cvt_pk_bf16_f32 v76, v47, v47
  v_cvt_pk_bf16_f32 v77, v47, v85
  v_cvt_pk_bf16_f32 v78, v46, v46
  v_cvt_pk_bf16_f32 v79, v46, v46
  ds_write_b128 v5, v[76:79] offset:0
  s_branch L_kb2
L_kb1:
  s_nop 0
  v_cvt_pk_bf16_f32 v80, v34, v33
  v_cvt_pk_bf16_f32 v81, v40, v40
  v_cvt_pk_bf16_f32 v82, v44, v44
  v_cvt_pk_bf16_f32 v83, v46, v46
  v_cvt_pk_bf16_f32 v87, v32, 0
  v_mov_b32 v86, v80
  s_mov_b64 exec, 1
  ds_write_b64 v5, v[86:87] offset:3088
  s_mov_b64 exec, -1
  v_readfirstlane_b32 s19, v81
  v_cvt_pk_bf16_f32 v65, v43, v39
  v_cvt_pk_bf16_f32 v66, v38, v37
  v_cvt_pk_bf16_f32 v67, v36, v35
  v_mov_b32 v64, s19
  v_mov_b32_dpp v64, v80 wave_shl:1 row_mask:0xf bank_mask:0xf
  ds_write_b128 v5, v[64:67] offset:3072
  v_readfirstlane_b32 s19, v82
  v_cvt_pk_bf16_f32 v69, v42, v42
  v_cvt_pk_bf16_f32 v70, v42, v41
  v_cvt_pk_bf16_f32 v71, v41, v41
  v_mov_b32 v68, s19
  v_mov_b32_dpp v68, v81 wave_shl:1 row_mask:0xf bank_mask:0xf
  ds_write_b128 v5, v[68:71] offset:2048
  v_readfirstlane_b32 s19, v83
  v_cvt_pk_bf16_f32 v73, v45, v45
  v_cvt_pk_bf16_f32 v74, v45, v45
  v_cvt_pk_bf16_f32 v75, v84, v44
  v_mov_b32_e64 v72, s19
  v_mov_b32_dpp v72, v82 wave_shl:1 row_mask:0xf bank_mask:0xf
  ds_write_b128 v5, v[72:75] offset:1024
  v_cvt_pk_bf16_f32 v77, v47, v47
  v_cvt_pk_bf16_f32 v78, v47, v47
  v_cvt_pk_bf16_f32 v79, v85, v46
  v_mov_b32 v76, s19
  v_mov_b32_dpp v76, v83 wave_shl:1 row_mask:0xf bank_mask:0xf
  ds_write_b128 v5, v[76:79] offset:0
L_kb2:
  s_mov_b64 exec, 1
  ds_add_u32 v14, v15 offset:49048
  s_mov_b64 exec, -1
  s_setprio 3
  v_accvgpr_read_b32 v5, a24
  v_accvgpr_read_b32 v6, a25
  v_accvgpr_read_b32 v7, a26
  s_cmp_lg_u32 s32, 0
  s_cbranch_scc1 L_nou
  ds_read_b32 v4, v14 offset:49040
  s_waitcnt lgkmcnt(0)
  v_cmp_gt_u32 vcc, 4, v4
  s_nop 0
  s_cbranch_vccz COK_55
  s_mov_b32 s66, 0x2000000
CLP_56:
  s_sleep 2
  ds_read_b32 v4, v14 offset:49040
  s_waitcnt lgkmcnt(0)
  v_cmp_gt_u32 vcc, 4, v4
  s_sub_u32 s66, s66, 1
  s_cbranch_scc1 COK_55
  s_cbranch_vccnz CLP_56
COK_55:
  s_mov_b32 s66, 0x100000
  s_branch L_uck
L_ulp:
  s_sleep 6
L_uck:
  s_buffer_load_dwordx16 s[76:91], s[48:51], s22 glc
  s_buffer_load_dword s31, s[48:51], s30 glc
  s_waitcnt lgkmcnt(0)
  s_xor_b64 s[76:77], s[76:77], s[64:65]
  s_xor_b64 s[78:79], s[78:79], s[64:65]
  s_xor_b64 s[80:81], s[80:81], s[64:65]
  s_xor_b64 s[82:83], s[82:83], s[64:65]
  s_xor_b64 s[84:85], s[84:85], s[64:65]
  s_xor_b64 s[86:87], s[86:87], s[64:65]
  s_xor_b64 s[88:89], s[88:89], s[64:65]
  s_xor_b64 s[90:91], s[90:91], s[64:65]
  s_xor_b32 s31, s31, s64
  s_or_b32 s76, s76, s31
  s_or_b64 s[76:77], s[76:77], s[78:79]
  s_or_b64 s[76:77], s[76:77], s[80:81]
  s_or_b64 s[76:77], s[76:77], s[82:83]
  s_or_b64 s[76:77], s[76:77], s[84:85]
  s_or_b64 s[76:77], s[76:77], s[86:87]
  s_or_b64 s[76:77], s[76:77], s[88:89]
  s_or_b64 s[76:77], s[76:77], s[90:91]
  s_cbranch_scc0 L_uok
  s_sub_u32 s66, s66, 1
  s_cbranch_scc0 L_ulp
L_uok:
  s_add_u32 m0, s28, 448
  s_add_u32 s24, s25, 0
  buffer_load_dwordx4 v3, s[48:51], s24 offen offset:0 sc1 lds
  buffer_load_dwordx4 v3, s[48:51], s24 offen offset:1024 sc1 lds
  s_add_u32 m0, s28, 5088
  s_add_u32 s24, s25, 4
  s_nop 0
  buffer_load_dwordx4 v3, s[48:51], s24 offen offset:0 sc1 lds
  buffer_load_dwordx4 v3, s[48:51], s24 offen offset:1024 sc1 lds
  s_add_u32 m0, s28, 9728
  s_add_u32 s24, s25, 4224
  buffer_load_dwordx4 v3, s[48:51], s24 offen offset:0 sc1 lds
  buffer_load_dwordx4 v3, s[48:51], s24 offen offset:1024 sc1 lds
  s_add_u32 m0, s28, 14368
  s_add_u32 s24, s25, 4228
  buffer_load_dwordx4 v3, s[48:51], s24 offen offset:0 sc1 lds
  buffer_load_dwordx4 v3, s[48:51], s24 offen offset:1024 sc1 lds
  s_mov_b32 exec_lo, 0x0fffffff
  s_mov_b32 exec_hi, 0
  s_add_u32 m0, s29, 0
  s_nop 0
  buffer_load_dwordx4 v3, s[48:51], s50 offen lds
  s_add_u32 m0, s29, 9280
  s_nop 0
  buffer_load_dwordx4 v3, s[48:51], s50 offen lds
  s_lshl_b32 m0, s3, 2
  s_add_u32 m0, m0, 28832
  s_mov_b64 exec, 1
  global_load_lds_dword v14, s[36:37]
  s_mov_b64 exec, -1
L_nou:
  ds_read_b32 v4, v14 offset:49048
  s_waitcnt lgkmcnt(0)
  v_cmp_gt_u32_e64 vcc, 8, v4
  s_nop 0
  s_cbranch_vccz COK_58
  s_mov_b32 s66, 0x2000000
CLP_59:
  ds_read_b32 v4, v14 offset:49048
  s_waitcnt lgkmcnt(0)
  v_cmp_gt_u32_e64 vcc, 8, v4
  s_sub_u32 s66, s66, 1
  s_cbranch_scc1 COK_58
  s_cbranch_vccnz CLP_59
COK_58:
  s_mov_b32 s66, 0x2000000
  s_branch L_uw1
L_uw0:
  s_sleep 1
L_uw1:
  ds_read_b64 v[124:125], v14 offset:28832
  s_waitcnt lgkmcnt(0)
  v_min_u32 v124, v124, v125
  v_cmp_eq_u32 vcc, 0, v124
  s_sub_u32 s66, s66, 1
  s_cbranch_scc1 L_uw2
  s_cbranch_vccnz L_uw0
L_uw2:
  v_accvgpr_read_b32 v34, a27
  buffer_load_dwordx4 a[64:67], v13, s[52:55], s74 offen
  buffer_load_dwordx4 a[68:71], v13, s[52:55], s75 offen
  global_load_dwordx4 a[72:75], v34, s[42:43]
  s_lshl_b32 s20, s35, 1
  s_add_u32 s20, s20, s9
  s_lshl_b32 s20, s20, 7
  s_add_u32 s20, s20, 14876672
  v_and_b32_e64 v9, 0x38, v1
  buffer_load_dword a76, v9, s[48:51], s20 offen offset:0 sc1
  buffer_load_dword a77, v9, s[48:51], s20 offen offset:64 sc1
  s_setprio 1
  s_cmp_eq_u32 s9, 0
  s_cbranch_scc0 L_cv1
  ds_read_b128 v[16:19], v6 offset:3520
  ds_read_b128 v[20:23], v6 offset:4032
  ds_read_b128 v[24:27], v6 offset:448
  ds_read_b128 v[28:31], v6 offset:960
  ds_read_b64 v[32:33], v5 offset:4032
  ds_read_b64 v[34:35], v5 offset:4040
  ds_read_b128 v[36:39], v6 offset:4032
  ds_read_b128 v[40:43], v6 offset:3520
  ds_read_b128 v[44:47], v6 offset:960
  ds_read_b128 v[48:51], v6 offset:448
  ds_read_b64 v[52:53], v5 offset:3520
  ds_read_b64 v[54:55], v5 offset:3528
  ds_read_b128 v[56:59], v6 offset:3008
  ds_read_b64 v[60:61], v5 offset:3008
  ds_read_b64 v[62:63], v5 offset:3016
  ds_read_b128 v[64:67], v6 offset:2496
  ds_read_b64 v[68:69], v5 offset:2496
  ds_read_b64 v[70:71], v5 offset:2504
  ds_read_b128 v[72:75], v6 offset:1984
  s_waitcnt lgkmcnt(15)
  v_lshlrev_b32 v20, 16, v21
  v_and_b32 v21, s14, v21
  v_lshlrev_b32 v22, 16, v23
  v_and_b32 v23, s14, v23
  v_mul_f32 v20, s72, v20
  v_mul_f32 v21, s72, v21
  v_mul_f32 v22, s72, v22
  v_mul_f32 v23, s72, v23
  v_lshlrev_b32 v16, 16, v17
  v_and_b32 v17, s14, v17
  v_lshlrev_b32 v18, 16, v19
  v_and_b32 v19, s14, v19
  v_mul_f32 v16, s72, v16
  v_mul_f32 v17, s72, v17
  v_mul_f32 v18, s72, v18
  v_mul_f32 v19, s72, v19
  v_lshlrev_b32 v28, 16, v29
  v_and_b32 v29, s14, v29
  v_lshlrev_b32 v30, 16, v31
  v_and_b32 v31, s14, v31
  v_mul_f32 v28, s72, v28
  v_mul_f32 v29, s72, v29
  v_mul_f32 v30, s72, v30
  v_mul_f32 v31, s72, v31
  v_lshlrev_b32 v24, 16, v25
  v_and_b32 v25, s14, v25
  v_lshlrev_b32 v26, 16, v27
  v_and_b32 v27, s14, v27
  v_mul_f32 v24, s72, v24
  v_mul_f32 v25, s72, v25
  v_mul_f32 v26, s72, v26
  v_mul_f32 v27, s72, v27
  s_waitcnt lgkmcnt(10)
  v_mfma_f32_16x16x32_bf16 v[20:23], v[32:35], v[36:39], v[20:23]
  ds_read_b64 v[76:77], v5 offset:1984
  ds_read_b64 v[78:79], v5 offset:1992
  v_mfma_f32_16x16x32_bf16 v[16:19], v[32:35], v[40:43], v[16:19]
  ds_read_b128 v[80:83], v6 offset:1472
  v_mfma_f32_16x16x32_bf16 v[28:31], v[32:35], v[44:47], v[28:31]
  ds_read_b64 v[84:85], v5 offset:1472
  ds_read_b64 v[86:87], v5 offset:1480
  s_waitcnt lgkmcnt(11)
  v_mfma_f32_16x16x32_bf16 v[24:27], v[32:35], v[48:51], v[24:27]
  v_mfma_f32_16x16x32_bf16 v[20:23], v[52:55], v[40:43], v[20:23]
  ds_read_b64 v[88:89], v5 offset:960
  ds_read_b64 v[90:91], v5 offset:968
  v_mfma_f32_16x16x32_bf16 v[16:19], v[52:55], v[56:59], v[16:19]
  s_waitcnt lgkmcnt(10)
  v_mfma_f32_16x16x32_bf16 v[28:31], v[52:55], v[48:51], v[28:31]
  ds_read_b64 v[92:93], v5 offset:448
  ds_read_b64 v[94:95], v5 offset:456
  v_mfma_f32_16x16x32_bf16 v[20:23], v[60:63], v[56:59], v[20:23]
  ds_read_b64 v[96:97], v5 offset:3968
  ds_read_b64 v[98:99], v5 offset:3976
  v_mfma_f32_16x16x32_bf16 v[16:19], v[60:63], v[64:67], v[16:19]
  ds_read_b128 v[100:103], v6 offset:3968
  s_waitcnt lgkmcnt(10)
  v_mfma_f32_16x16x32_bf16 v[20:23], v[68:71], v[64:67], v[20:23]
  ds_read_b128 v[104:107], v6 offset:3456
  v_mfma_f32_16x16x32_bf16 v[16:19], v[68:71], v[72:75], v[16:19]
  ds_read_b128 v[108:111], v6 offset:896
  v_mfma_f32_16x16x32_bf16 v[20:23], v[76:79], v[72:75], v[20:23]
  ds_read_b128 v[112:115], v6 offset:384
  s_waitcnt lgkmcnt(10)
  v_mfma_f32_16x16x32_bf16 v[16:19], v[76:79], v[80:83], v[16:19]
  ds_read_b64 v[116:117], v5 offset:3456
  ds_read_b64 v[118:119], v5 offset:3464
  v_mfma_f32_16x16x32_bf16 v[20:23], v[84:87], v[80:83], v[20:23]
  ds_read_b128 v[120:123], v6 offset:2944
  v_mfma_f32_16x16x32_bf16 v[16:19], v[84:87], v[44:47], v[16:19]
  ds_read_b64 v[124:125], v5 offset:2944
  ds_read_b64 v[126:127], v5 offset:2952
  s_waitcnt lgkmcnt(11)
  v_mfma_f32_16x16x32_bf16 v[20:23], v[88:91], v[44:47], v[20:23]
  ds_read_b128 v[36:39], v6 offset:2432
  v_mfma_f32_16x16x32_bf16 v[16:19], v[88:91], v[48:51], v[16:19]
  ds_read_b64 v[32:33], v5 offset:2432
  ds_read_b64 v[34:35], v5 offset:2440
  v_mfma_f32_16x16x32_bf16 v[20:23], v[92:95], v[48:51], v[20:23]
  ds_read_b128 v[40:43], v6 offset:1920
  s_waitcnt lgkmcnt(10)
  v_mfma_f32_16x16x32_bf16 v[20:23], v[96:99], v[100:103], v[20:23]
  ds_read_b64 v[52:53], v5 offset:1920
  ds_read_b64 v[54:55], v5 offset:1928
  v_mfma_f32_16x16x32_bf16 v[16:19], v[96:99], v[104:107], v[16:19]
  ds_read_b128 v[56:59], v6 offset:1408
  v_mfma_f32_16x16x32_bf16 v[28:31], v[96:99], v[108:111], v[28:31]
  ds_read_b64 v[60:61], v5 offset:1408
  ds_read_b64 v[62:63], v5 offset:1416
  s_waitcnt lgkmcnt(11)
  v_mfma_f32_16x16x32_bf16 v[24:27], v[96:99], v[112:115], v[24:27]
  v_mfma_f32_16x16x32_bf16 v[20:23], v[116:119], v[104:107], v[20:23]
  ds_read_b64 v[64:65], v5 offset:896
  ds_read_b64 v[66:67], v5 offset:904
  v_mfma_f32_16x16x32_bf16 v[16:19], v[116:119], v[120:123], v[16:19]
  s_waitcnt lgkmcnt(10)
  v_mfma_f32_16x16x32_bf16 v[28:31], v[116:119], v[112:115], v[28:31]
  ds_read_b64 v[68:69], v5 offset:384
  ds_read_b64 v[70:71], v5 offset:392
  v_mfma_f32_16x16x32_bf16 v[20:23], v[124:127], v[120:123], v[20:23]
  ds_read_b64 v[72:73], v5 offset:3904
  ds_read_b64 v[74:75], v5 offset:3912
  v_mfma_f32_16x16x32_bf16 v[16:19], v[124:127], v[36:39], v[16:19]
  ds_read_b128 v[76:79], v6 offset:3904
  s_waitcnt lgkmcnt(10)
  v_mfma_f32_16x16x32_bf16 v[20:23], v[32:35], v[36:39], v[20:23]
  ds_read_b128 v[80:83], v6 offset:3392
  v_mfma_f32_16x16x32_bf16 v[16:19], v[32:35], v[40:43], v[16:19]
  ds_read_b128 v[84:87], v6 offset:832
  v_mfma_f32_16x16x32_bf16 v[20:23], v[52:55], v[40:43], v[20:23]
  ds_read_b128 v[44:47], v6 offset:320
  s_waitcnt lgkmcnt(10)
  v_mfma_f32_16x16x32_bf16 v[16:19], v[52:55], v[56:59], v[16:19]
  ds_read_b64 v[88:89], v5 offset:3392
  ds_read_b64 v[90:91], v5 offset:3400
  v_mfma_f32_16x16x32_bf16 v[20:23], v[60:63], v[56:59], v[20:23]
  ds_read_b128 v[92:95], v6 offset:2880
  v_mfma_f32_16x16x32_bf16 v[16:19], v[60:63], v[108:111], v[16:19]
  ds_read_b64 v[48:49], v5 offset:2880
  ds_read_b64 v[50:51], v5 offset:2888
  s_waitcnt lgkmcnt(11)
  v_mfma_f32_16x16x32_bf16 v[20:23], v[64:67], v[108:111], v[20:23]
  ds_read_b128 v[100:103], v6 offset:2368
  v_mfma_f32_16x16x32_bf16 v[16:19], v[64:67], v[112:115], v[16:19]
  ds_read_b64 v[96:97], v5 offset:2368
  ds_read_b64 v[98:99], v5 offset:2376
  v_mfma_f32_16x16x32_bf16 v[20:23], v[68:71], v[112:115], v[20:23]
  ds_read_b128 v[104:107], v6 offset:1856
  s_waitcnt lgkmcnt(10)
  v_mfma_f32_16x16x32_bf16 v[20:23], v[72:75], v[76:79], v[20:23]
  ds_read_b64 v[116:117], v5 offset:1856
  ds_read_b64 v[118:119], v5 offset:1864
  v_mfma_f32_16x16x32_bf16 v[16:19], v[72:75], v[80:83], v[16:19]
  ds_read_b128 v[120:123], v6 offset:1344
  v_mfma_f32_16x16x32_bf16 v[28:31], v[72:75], v[84:87], v[28:31]
  ds_read_b64 v[124:125], v5 offset:1344
  ds_read_b64 v[126:127], v5 offset:1352
  s_waitcnt lgkmcnt(11)
  v_mfma_f32_16x16x32_bf16 v[24:27], v[72:75], v[44:47], v[24:27]
  v_mfma_f32_16x16x32_bf16 v[20:23], v[88:91], v[80:83], v[20:23]
  ds_read_b64 v[36:37], v5 offset:832
  ds_read_b64 v[38:39], v5 offset:840
  v_mfma_f32_16x16x32_bf16 v[16:19], v[88:91], v[92:95], v[16:19]
  s_waitcnt lgkmcnt(10)
  v_mfma_f32_16x16x32_bf16 v[28:31], v[88:91], v[44:47], v[28:31]
  ds_read_b64 v[32:33], v5 offset:320
  ds_read_b64 v[34:35], v5 offset:328
  v_mfma_f32_16x16x32_bf16 v[20:23], v[48:51], v[92:95], v[20:23]
  ds_read_b64 v[40:41], v5 offset:3840
  ds_read_b64 v[42:43], v5 offset:3848
  v_mfma_f32_16x16x32_bf16 v[16:19], v[48:51], v[100:103], v[16:19]
  ds_read_b128 v[52:55], v6 offset:3840
  s_waitcnt lgkmcnt(10)
  v_mfma_f32_16x16x32_bf16 v[20:23], v[96:99], v[100:103], v[20:23]
  ds_read_b128 v[56:59], v6 offset:3328
  v_mfma_f32_16x16x32_bf16 v[16:19], v[96:99], v[104:107], v[16:19]
  ds_read_b128 v[60:63], v6 offset:768
  v_mfma_f32_16x16x32_bf16 v[20:23], v[116:119], v[104:107], v[20:23]
  ds_read_b128 v[108:111], v6 offset:256
  s_waitcnt lgkmcnt(10)
  v_mfma_f32_16x16x32_bf16 v[16:19], v[116:119], v[120:123], v[16:19]
  ds_read_b64 v[64:65], v5 offset:3328
  ds_read_b64 v[66:67], v5 offset:3336
  v_mfma_f32_16x16x32_bf16 v[20:23], v[124:127], v[120:123], v[20:23]
  ds_read_b128 v[68:71], v6 offset:2816
  v_mfma_f32_16x16x32_bf16 v[16:19], v[124:127], v[84:87], v[16:19]
  ds_read_b64 v[112:113], v5 offset:2816
  ds_read_b64 v[114:115], v5 offset:2824
  s_waitcnt lgkmcnt(11)
  v_mfma_f32_16x16x32_bf16 v[20:23], v[36:39], v[84:87], v[20:23]
  ds_read_b128 v[76:79], v6 offset:2304
  v_mfma_f32_16x16x32_bf16 v[16:19], v[36:39], v[44:47], v[16:19]
  ds_read_b64 v[72:73], v5 offset:2304
  ds_read_b64 v[74:75], v5 offset:2312
  v_mfma_f32_16x16x32_bf16 v[20:23], v[32:35], v[44:47], v[20:23]
  ds_read_b128 v[80:83], v6 offset:1792
  s_waitcnt lgkmcnt(10)
  v_mfma_f32_16x16x32_bf16 v[20:23], v[40:43], v[52:55], v[20:23]
  ds_read_b64 v[88:89], v5 offset:1792
  ds_read_b64 v[90:91], v5 offset:1800
  v_mfma_f32_16x16x32_bf16 v[16:19], v[40:43], v[56:59], v[16:19]
  ds_read_b128 v[92:95], v6 offset:1280
  v_mfma_f32_16x16x32_bf16 v[28:31], v[40:43], v[60:63], v[28:31]
  ds_read_b64 v[48:49], v5 offset:1280
  ds_read_b64 v[50:51], v5 offset:1288
  s_waitcnt lgkmcnt(11)
  v_mfma_f32_16x16x32_bf16 v[24:27], v[40:43], v[108:111], v[24:27]
  v_mfma_f32_16x16x32_bf16 v[20:23], v[64:67], v[56:59], v[20:23]
  ds_read_b64 v[100:101], v5 offset:768
  ds_read_b64 v[102:103], v5 offset:776
  v_mfma_f32_16x16x32_bf16 v[16:19], v[64:67], v[68:71], v[16:19]
  s_waitcnt lgkmcnt(10)
  v_mfma_f32_16x16x32_bf16 v[28:31], v[64:67], v[108:111], v[28:31]
  ds_read_b64 v[96:97], v5 offset:256
  ds_read_b64 v[98:99], v5 offset:264
  v_mfma_f32_16x16x32_bf16 v[20:23], v[112:115], v[68:71], v[20:23]
  ds_read_b64 v[104:105], v5 offset:3776
  ds_read_b64 v[106:107], v5 offset:3784
  v_mfma_f32_16x16x32_bf16 v[16:19], v[112:115], v[76:79], v[16:19]
  ds_read_b128 v[116:119], v6 offset:3776
  s_waitcnt lgkmcnt(10)
  v_mfma_f32_16x16x32_bf16 v[20:23], v[72:75], v[76:79], v[20:23]
  ds_read_b128 v[120:123], v6 offset:3264
  v_mfma_f32_16x16x32_bf16 v[16:19], v[72:75], v[80:83], v[16:19]
  ds_read_b128 v[124:127], v6 offset:704
  v_mfma_f32_16x16x32_bf16 v[20:23], v[88:91], v[80:83], v[20:23]
  ds_read_b128 v[84:87], v6 offset:192
  s_waitcnt lgkmcnt(10)
  v_mfma_f32_16x16x32_bf16 v[16:19], v[88:91], v[92:95], v[16:19]
  ds_read_b64 v[36:37], v5 offset:3264
  ds_read_b64 v[38:39], v5 offset:3272
  v_mfma_f32_16x16x32_bf16 v[20:23], v[48:51], v[92:95], v[20:23]
  ds_read_b128 v[32:35], v6 offset:2752
  v_mfma_f32_16x16x32_bf16 v[16:19], v[48:51], v[60:63], v[16:19]
  ds_read_b64 v[44:45], v5 offset:2752
  ds_read_b64 v[46:47], v5 offset:2760
  s_waitcnt lgkmcnt(11)
  v_mfma_f32_16x16x32_bf16 v[20:23], v[100:103], v[60:63], v[20:23]
  ds_read_b128 v[52:55], v6 offset:2240
  v_mfma_f32_16x16x32_bf16 v[16:19], v[100:103], v[108:111], v[16:19]
  ds_read_b64 v[40:41], v5 offset:2240
  ds_read_b64 v[42:43], v5 offset:2248
  v_mfma_f32_16x16x32_bf16 v[20:23], v[96:99], v[108:111], v[20:23]
  ds_read_b128 v[56:59], v6 offset:1728
  s_waitcnt lgkmcnt(10)
  v_mfma_f32_16x16x32_bf16 v[20:23], v[104:107], v[116:119], v[20:23]
  ds_read_b64 v[64:65], v5 offset:1728
  ds_read_b64 v[66:67], v5 offset:1736
  v_mfma_f32_16x16x32_bf16 v[16:19], v[104:107], v[120:123], v[16:19]
  ds_read_b128 v[68:71], v6 offset:1216
  v_mfma_f32_16x16x32_bf16 v[28:31], v[104:107], v[124:127], v[28:31]
  ds_read_b64 v[112:113], v5 offset:1216
  ds_read_b64 v[114:115], v5 offset:1224
  s_waitcnt lgkmcnt(11)
  v_mfma_f32_16x16x32_bf16 v[24:27], v[104:107], v[84:87], v[24:27]
  v_mfma_f32_16x16x32_bf16 v[20:23], v[36:39], v[120:123], v[20:23]
  ds_read_b64 v[76:77], v5 offset:704
  ds_read_b64 v[78:79], v5 offset:712
  v_mfma_f32_16x16x32_bf16 v[16:19], v[36:39], v[32:35], v[16:19]
  s_waitcnt lgkmcnt(10)
  v_mfma_f32_16x16x32_bf16 v[28:31], v[36:39], v[84:87], v[28:31]
  ds_read_b64 v[72:73], v5 offset:192
  ds_read_b64 v[74:75], v5 offset:200
  v_mfma_f32_16x16x32_bf16 v[20:23], v[44:47], v[32:35], v[20:23]
  ds_read_b64 v[80:81], v5 offset:3712
  ds_read_b64 v[82:83], v5 offset:3720
  v_mfma_f32_16x16x32_bf16 v[16:19], v[44:47], v[52:55], v[16:19]
  ds_read_b128 v[88:91], v6 offset:3712
  s_waitcnt lgkmcnt(10)
  v_mfma_f32_16x16x32_bf16 v[20:23], v[40:43], v[52:55], v[20:23]
  ds_read_b128 v[92:95], v6 offset:3200
  v_mfma_f32_16x16x32_bf16 v[16:19], v[40:43], v[56:59], v[16:19]
  ds_read_b128 v[48:51], v6 offset:640
  v_mfma_f32_16x16x32_bf16 v[20:23], v[64:67], v[56:59], v[20:23]
  ds_read_b128 v[60:63], v6 offset:128
  s_waitcnt lgkmcnt(10)
  v_mfma_f32_16x16x32_bf16 v[16:19], v[64:67], v[68:71], v[16:19]
  ds_read_b64 v[100:101], v5 offset:3200
  ds_read_b64 v[102:103], v5 offset:3208
  v_mfma_f32_16x16x32_bf16 v[20:23], v[112:115], v[68:71], v[20:23]
  ds_read_b128 v[96:99], v6 offset:2688
  v_mfma_f32_16x16x32_bf16 v[16:19], v[112:115], v[124:127], v[16:19]
  ds_read_b64 v[108:109], v5 offset:2688
  ds_read_b64 v[110:111], v5 offset:2696
  s_waitcnt lgkmcnt(11)
  v_mfma_f32_16x16x32_bf16 v[20:23], v[76:79], v[124:127], v[20:23]
  ds_read_b128 v[116:119], v6 offset:2176
  v_mfma_f32_16x16x32_bf16 v[16:19], v[76:79], v[84:87], v[16:19]
  ds_read_b64 v[104:105], v5 offset:2176
  ds_read_b64 v[106:107], v5 offset:2184
  v_mfma_f32_16x16x32_bf16 v[20:23], v[72:75], v[84:87], v[20:23]
  ds_read_b128 v[120:123], v6 offset:1664
  s_waitcnt lgkmcnt(10)
  v_mfma_f32_16x16x32_bf16 v[20:23], v[80:83], v[88:91], v[20:23]
  ds_read_b64 v[36:37], v5 offset:1664
  ds_read_b64 v[38:39], v5 offset:1672
  v_mfma_f32_16x16x32_bf16 v[16:19], v[80:83], v[92:95], v[16:19]
  ds_read_b128 v[32:35], v6 offset:1152
  v_mfma_f32_16x16x32_bf16 v[28:31], v[80:83], v[48:51], v[28:31]
  ds_read_b64 v[44:45], v5 offset:1152
  ds_read_b64 v[46:47], v5 offset:1160
  s_waitcnt lgkmcnt(11)
  v_mfma_f32_16x16x32_bf16 v[24:27], v[80:83], v[60:63], v[24:27]
  v_mfma_f32_16x16x32_bf16 v[20:23], v[100:103], v[92:95], v[20:23]
  ds_read_b64 v[52:53], v5 offset:640
  ds_read_b64 v[54:55], v5 offset:648
  v_mfma_f32_16x16x32_bf16 v[16:19], v[100:103], v[96:99], v[16:19]
  s_waitcnt lgkmcnt(10)
  v_mfma_f32_16x16x32_bf16 v[28:31], v[100:103], v[60:63], v[28:31]
  ds_read_b64 v[40:41], v5 offset:128
  ds_read_b64 v[42:43], v5 offset:136
  v_mfma_f32_16x16x32_bf16 v[20:23], v[108:111], v[96:99], v[20:23]
  ds_read_b64 v[56:57], v5 offset:3648
  ds_read_b64 v[58:59], v5 offset:3656
  v_mfma_f32_16x16x32_bf16 v[16:19], v[108:111], v[116:119], v[16:19]
  ds_read_b128 v[64:67], v6 offset:3648
  s_waitcnt lgkmcnt(10)
  v_mfma_f32_16x16x32_bf16 v[20:23], v[104:107], v[116:119], v[20:23]
  ds_read_b128 v[68:71], v6 offset:3136
  v_mfma_f32_16x16x32_bf16 v[16:19], v[104:107], v[120:123], v[16:19]
  ds_read_b128 v[112:115], v6 offset:576
  v_mfma_f32_16x16x32_bf16 v[20:23], v[36:39], v[120:123], v[20:23]
  ds_read_b128 v[124:127], v6 offset:64
  s_waitcnt lgkmcnt(10)
  v_mfma_f32_16x16x32_bf16 v[16:19], v[36:39], v[32:35], v[16:19]
  ds_read_b64 v[76:77], v5 offset:3136
  ds_read_b64 v[78:79], v5 offset:3144
  v_mfma_f32_16x16x32_bf16 v[20:23], v[44:47], v[32:35], v[20:23]
  ds_read_b128 v[72:75], v6 offset:2624
  v_mfma_f32_16x16x32_bf16 v[16:19], v[44:47], v[48:51], v[16:19]
  ds_read_b64 v[84:85], v5 offset:2624
  ds_read_b64 v[86:87], v5 offset:2632
  s_waitcnt lgkmcnt(11)
  v_mfma_f32_16x16x32_bf16 v[20:23], v[52:55], v[48:51], v[20:23]
  ds_read_b128 v[88:91], v6 offset:2112
  v_mfma_f32_16x16x32_bf16 v[16:19], v[52:55], v[60:63], v[16:19]
  ds_read_b64 v[80:81], v5 offset:2112
  ds_read_b64 v[82:83], v5 offset:2120
  v_mfma_f32_16x16x32_bf16 v[20:23], v[40:43], v[60:63], v[20:23]
  ds_read_b128 v[92:95], v6 offset:1600
  s_waitcnt lgkmcnt(10)
  v_mfma_f32_16x16x32_bf16 v[20:23], v[56:59], v[64:67], v[20:23]
  ds_read_b64 v[100:101], v5 offset:1600
  ds_read_b64 v[102:103], v5 offset:1608
  v_mfma_f32_16x16x32_bf16 v[16:19], v[56:59], v[68:71], v[16:19]
  ds_read_b128 v[96:99], v6 offset:1088
  v_mfma_f32_16x16x32_bf16 v[28:31], v[56:59], v[112:115], v[28:31]
  ds_read_b64 v[108:109], v5 offset:1088
  ds_read_b64 v[110:111], v5 offset:1096
  s_waitcnt lgkmcnt(11)
  v_mfma_f32_16x16x32_bf16 v[24:27], v[56:59], v[124:127], v[24:27]
  v_mfma_f32_16x16x32_bf16 v[20:23], v[76:79], v[68:71], v[20:23]
  ds_read_b64 v[116:117], v5 offset:576
  ds_read_b64 v[118:119], v5 offset:584
  v_mfma_f32_16x16x32_bf16 v[16:19], v[76:79], v[72:75], v[16:19]
  s_waitcnt lgkmcnt(10)
  v_mfma_f32_16x16x32_bf16 v[28:31], v[76:79], v[124:127], v[28:31]
  ds_read_b64 v[104:105], v5 offset:64
  ds_read_b64 v[106:107], v5 offset:72
  v_mfma_f32_16x16x32_bf16 v[20:23], v[84:87], v[72:75], v[20:23]
  ds_read_b64 v[120:121], v5 offset:3584
  ds_read_b64 v[122:123], v5 offset:3592
  v_mfma_f32_16x16x32_bf16 v[16:19], v[84:87], v[88:91], v[16:19]
  ds_read_b128 v[36:39], v6 offset:3584
  s_waitcnt lgkmcnt(10)
  v_mfma_f32_16x16x32_bf16 v[20:23], v[80:83], v[88:91], v[20:23]
  ds_read_b128 v[32:35], v6 offset:3072
  v_mfma_f32_16x16x32_bf16 v[16:19], v[80:83], v[92:95], v[16:19]
  ds_read_b128 v[44:47], v6 offset:512
  v_mfma_f32_16x16x32_bf16 v[20:23], v[100:103], v[92:95], v[20:23]
  ds_read_b128 v[48:51], v6 offset:0
  s_waitcnt lgkmcnt(10)
  v_mfma_f32_16x16x32_bf16 v[16:19], v[100:103], v[96:99], v[16:19]
  ds_read_b64 v[52:53], v5 offset:3072
  ds_read_b64 v[54:55], v5 offset:3080
  v_mfma_f32_16x16x32_bf16 v[20:23], v[108:111], v[96:99], v[20:23]
  ds_read_b128 v[40:43], v6 offset:2560
  v_mfma_f32_16x16x32_bf16 v[16:19], v[108:111], v[112:115], v[16:19]
  ds_read_b64 v[60:61], v5 offset:2560
  ds_read_b64 v[62:63], v5 offset:2568
  s_waitcnt lgkmcnt(11)
  v_mfma_f32_16x16x32_bf16 v[20:23], v[116:119], v[112:115], v[20:23]
  ds_read_b128 v[64:67], v6 offset:2048
  v_mfma_f32_16x16x32_bf16 v[16:19], v[116:119], v[124:127], v[16:19]
  ds_read_b64 v[56:57], v5 offset:2048
  ds_read_b64 v[58:59], v5 offset:2056
  v_mfma_f32_16x16x32_bf16 v[20:23], v[104:107], v[124:127], v[20:23]
  ds_read_b128 v[68:71], v6 offset:1536
  s_waitcnt lgkmcnt(10)
  v_mfma_f32_16x16x32_bf16 v[20:23], v[120:123], v[36:39], v[20:23]
  ds_read_b64 v[76:77], v5 offset:1536
  ds_read_b64 v[78:79], v5 offset:1544
  v_mfma_f32_16x16x32_bf16 v[16:19], v[120:123], v[32:35], v[16:19]
  ds_read_b128 v[72:75], v6 offset:1024
  v_mfma_f32_16x16x32_bf16 v[28:31], v[120:123], v[44:47], v[28:31]
  ds_read_b64 v[84:85], v5 offset:1024
  ds_read_b64 v[86:87], v5 offset:1032
  s_waitcnt lgkmcnt(11)
  v_mfma_f32_16x16x32_bf16 v[24:27], v[120:123], v[48:51], v[24:27]
  v_mfma_f32_16x16x32_bf16 v[20:23], v[52:55], v[32:35], v[20:23]
  ds_read_b64 v[88:89], v5 offset:512
  ds_read_b64 v[90:91], v5 offset:520
  v_mfma_f32_16x16x32_bf16 v[16:19], v[52:55], v[40:43], v[16:19]
  s_waitcnt lgkmcnt(10)
  v_mfma_f32_16x16x32_bf16 v[28:31], v[52:55], v[48:51], v[28:31]
  ds_read_b64 v[80:81], v5 offset:0
  ds_read_b64 v[82:83], v5 offset:8
  s_mov_b64 exec, 1
  ds_add_u32 v14, v15 offset:49056
  s_mov_b64 exec, -1
  v_mfma_f32_16x16x32_bf16 v[20:23], v[60:63], v[40:43], v[20:23]
  v_mfma_f32_16x16x32_bf16 v[16:19], v[60:63], v[64:67], v[16:19]
  s_waitcnt lgkmcnt(8)
  v_mfma_f32_16x16x32_bf16 v[20:23], v[56:59], v[64:67], v[20:23]
  v_mfma_f32_16x16x32_bf16 v[16:19], v[56:59], v[68:71], v[16:19]
  v_mfma_f32_16x16x32_bf16 v[20:23], v[76:79], v[68:71], v[20:23]
  s_waitcnt lgkmcnt(5)
  v_mfma_f32_16x16x32_bf16 v[16:19], v[76:79], v[72:75], v[16:19]
  v_mfma_f32_16x16x32_bf16 v[20:23], v[84:87], v[72:75], v[20:23]
  v_mfma_f32_16x16x32_bf16 v[16:19], v[84:87], v[44:47], v[16:19]
  s_waitcnt lgkmcnt(1)
  v_mfma_f32_16x16x32_bf16 v[20:23], v[88:91], v[44:47], v[20:23]
  v_mfma_f32_16x16x32_bf16 v[16:19], v[88:91], v[48:51], v[16:19]
  v_mfma_f32_16x16x32_bf16 v[20:23], v[80:83], v[48:51], v[20:23]
  s_branch L_cv2
L_cv1:
  ds_read_b128 v[16:19], v6 offset:2496
  ds_read_b128 v[20:23], v6 offset:3008
  ds_read_b128 v[24:27], v6 offset:1472
  ds_read_b128 v[28:31], v6 offset:1984
  ds_read_b64 v[32:33], v5 offset:4032
  ds_read_b64 v[34:35], v5 offset:4040
  ds_read_b128 v[36:39], v6 offset:3008
  ds_read_b128 v[40:43], v6 offset:2496
  ds_read_b128 v[44:47], v6 offset:1984
  ds_read_b128 v[48:51], v6 offset:1472
  ds_read_b64 v[52:53], v5 offset:3520
  ds_read_b64 v[54:55], v5 offset:3528
  ds_read_b128 v[56:59], v6 offset:960
  ds_read_b64 v[60:61], v5 offset:3008
  ds_read_b64 v[62:63], v5 offset:3016
  s_waitcnt lgkmcnt(13)
  v_lshlrev_b32 v20, 16, v21
  v_and_b32 v21, s14, v21
  v_lshlrev_b32 v22, 16, v23
  v_and_b32 v23, s14, v23
  v_mul_f32 v20, s72, v20
  v_mul_f32 v21, s72, v21
  v_mul_f32 v22, s72, v22
  v_mul_f32 v23, s72, v23
  v_lshlrev_b32 v16, 16, v17
  v_and_b32 v17, s14, v17
  v_lshlrev_b32 v18, 16, v19
  v_and_b32 v19, s14, v19
  v_mul_f32 v16, s72, v16
  v_mul_f32 v17, s72, v17
  v_mul_f32 v18, s72, v18
  v_mul_f32 v19, s72, v19
  s_waitcnt lgkmcnt(11)
  v_lshlrev_b32 v28, 16, v29
  v_and_b32 v29, s14, v29
  v_lshlrev_b32 v30, 16, v31
  v_and_b32 v31, s14, v31
  v_mul_f32 v28, s72, v28
  v_mul_f32 v29, s72, v29
  v_mul_f32 v30, s72, v30
  v_mul_f32 v31, s72, v31
  v_lshlrev_b32 v24, 16, v25
  v_and_b32 v25, s14, v25
  v_lshlrev_b32 v26, 16, v27
  v_and_b32 v27, s14, v27
  v_mul_f32 v24, s72, v24
  v_mul_f32 v25, s72, v25
  v_mul_f32_e64 v26, s72, v26
  v_mul_f32 v27, s72, v27
  s_waitcnt lgkmcnt(6)
  v_mfma_f32_16x16x32_bf16 v[20:23], v[32:35], v[36:39], v[20:23]
  ds_read_b128 v[64:67], v6 offset:448
  v_mfma_f32_16x16x32_bf16 v[16:19], v[32:35], v[40:43], v[16:19]
  ds_read_b64 v[68:69], v5 offset:2496
  ds_read_b64 v[70:71], v5 offset:2504
  v_mfma_f32_16x16x32_bf16 v[28:31], v[32:35], v[44:47], v[28:31]
  s_waitcnt lgkmcnt(6)
  v_mfma_f32_16x16x32_bf16 v[24:27], v[32:35], v[48:51], v[24:27]
  v_mfma_f32_16x16x32_bf16 v[20:23], v[52:55], v[40:43], v[20:23]
  ds_read_b64 v[72:73], v5 offset:1984
  ds_read_b64 v[74:75], v5 offset:1992
  v_mfma_f32_16x16x32_bf16 v[16:19], v[52:55], v[44:47], v[16:19]
  s_waitcnt lgkmcnt(5)
  v_mfma_f32_16x16x32_bf16 v[28:31], v[52:55], v[48:51], v[28:31]
  ds_read_b64 v[76:77], v5 offset:1472
  ds_read_b64 v[78:79], v5 offset:1480
  v_mfma_f32_16x16x32_bf16 v[24:27], v[52:55], v[56:59], v[24:27]
  ds_read_b64 v[80:81], v5 offset:3968
  ds_read_b64 v[82:83], v5 offset:3976
  v_mfma_f32_16x16x32_bf16 v[20:23], v[60:63], v[44:47], v[20:23]
  ds_read_b128 v[84:87], v6 offset:2944
  s_waitcnt lgkmcnt(9)
  v_mfma_f32_16x16x32_bf16 v[16:19], v[60:63], v[48:51], v[16:19]
  ds_read_b128 v[88:91], v6 offset:2432
  v_mfma_f32_16x16x32_bf16 v[28:31], v[60:63], v[56:59], v[28:31]
  ds_read_b128 v[92:95], v6 offset:1920
  v_mfma_f32_16x16x32_bf16 v[24:27], v[60:63], v[64:67], v[24:27]
  ds_read_b128 v[96:99], v6 offset:1408
  s_waitcnt lgkmcnt(10)
  v_mfma_f32_16x16x32_bf16 v[20:23], v[68:71], v[48:51], v[20:23]
  ds_read_b64 v[100:101], v5 offset:3456
  ds_read_b64 v[102:103], v5 offset:3464
  v_mfma_f32_16x16x32_bf16 v[16:19], v[68:71], v[56:59], v[16:19]
  v_mfma_f32_16x16x32_bf16 v[28:31], v[68:71], v[64:67], v[28:31]
  ds_read_b128 v[104:107], v6 offset:896
  s_waitcnt lgkmcnt(9)
  v_mfma_f32_16x16x32_bf16 v[20:23], v[72:75], v[56:59], v[20:23]
  ds_read_b64 v[108:109], v5 offset:2944
  ds_read_b64 v[110:111], v5 offset:2952
  v_mfma_f32_16x16x32_bf16 v[16:19], v[72:75], v[64:67], v[16:19]
  v_mfma_f32_16x16x32_bf16 v[20:23], v[76:79], v[64:67], v[20:23]
  s_waitcnt lgkmcnt(6)
  v_mfma_f32_16x16x32_bf16 v[20:23], v[80:83], v[84:87], v[20:23]
  ds_read_b128 v[112:115], v6 offset:384
  v_mfma_f32_16x16x32_bf16 v[16:19], v[80:83], v[88:91], v[16:19]
  ds_read_b64 v[116:117], v5 offset:2432
  ds_read_b64 v[118:119], v5 offset:2440
  v_mfma_f32_16x16x32_bf16 v[28:31], v[80:83], v[92:95], v[28:31]
  s_waitcnt lgkmcnt(6)
  v_mfma_f32_16x16x32_bf16 v[24:27], v[80:83], v[96:99], v[24:27]
  v_mfma_f32_16x16x32_bf16 v[20:23], v[100:103], v[88:91], v[20:23]
  ds_read_b64 v[120:121], v5 offset:1920
  ds_read_b64 v[122:123], v5 offset:1928
  v_mfma_f32_16x16x32_bf16 v[16:19], v[100:103], v[92:95], v[16:19]
  s_waitcnt lgkmcnt(5)
  v_mfma_f32_16x16x32_bf16 v[28:31], v[100:103], v[96:99], v[28:31]
  ds_read_b64 v[124:125], v5 offset:1408
  ds_read_b64 v[126:127], v5 offset:1416
  v_mfma_f32_16x16x32_bf16 v[24:27], v[100:103], v[104:107], v[24:27]
  ds_read_b64 v[36:37], v5 offset:3904
  ds_read_b64 v[38:39], v5 offset:3912
  v_mfma_f32_16x16x32_bf16 v[20:23], v[108:111], v[92:95], v[20:23]
  ds_read_b128 v[32:35], v6 offset:2880
  s_waitcnt lgkmcnt(9)
  v_mfma_f32_16x16x32_bf16 v[16:19], v[108:111], v[96:99], v[16:19]
  ds_read_b128 v[40:43], v6 offset:2368
  v_mfma_f32_16x16x32_bf16 v[28:31], v[108:111], v[104:107], v[28:31]
  ds_read_b128 v[52:55], v6 offset:1856
  v_mfma_f32_16x16x32_bf16 v[24:27], v[108:111], v[112:115], v[24:27]
  ds_read_b128 v[44:47], v6 offset:1344
  s_waitcnt lgkmcnt(10)
  v_mfma_f32_16x16x32_bf16 v[20:23], v[116:119], v[96:99], v[20:23]
  ds_read_b64 v[60:61], v5 offset:3392
  ds_read_b64 v[62:63], v5 offset:3400
  v_mfma_f32_16x16x32_bf16 v[16:19], v[116:119], v[104:107], v[16:19]
  v_mfma_f32_16x16x32_bf16 v[28:31], v[116:119], v[112:115], v[28:31]
  ds_read_b128 v[48:51], v6 offset:832
  s_waitcnt lgkmcnt(9)
  v_mfma_f32_16x16x32_bf16 v[20:23], v[120:123], v[104:107], v[20:23]
  ds_read_b64 v[68:69], v5 offset:2880
  ds_read_b64 v[70:71], v5 offset:2888
  v_mfma_f32_16x16x32_bf16 v[16:19], v[120:123], v[112:115], v[16:19]
  v_mfma_f32_16x16x32_bf16 v[20:23], v[124:127], v[112:115], v[20:23]
  s_waitcnt lgkmcnt(6)
  v_mfma_f32_16x16x32_bf16 v[20:23], v[36:39], v[32:35], v[20:23]
  ds_read_b128 v[56:59], v6 offset:320
  v_mfma_f32_16x16x32_bf16 v[16:19], v[36:39], v[40:43], v[16:19]
  ds_read_b64 v[72:73], v5 offset:2368
  ds_read_b64 v[74:75], v5 offset:2376
  v_mfma_f32_16x16x32_bf16 v[28:31], v[36:39], v[52:55], v[28:31]
  s_waitcnt lgkmcnt(6)
  v_mfma_f32_16x16x32_bf16 v[24:27], v[36:39], v[44:47], v[24:27]
  v_mfma_f32_16x16x32_bf16 v[20:23], v[60:63], v[40:43], v[20:23]
  ds_read_b64 v[76:77], v5 offset:1856
  ds_read_b64 v[78:79], v5 offset:1864
  v_mfma_f32_16x16x32_bf16 v[16:19], v[60:63], v[52:55], v[16:19]
  s_waitcnt lgkmcnt(5)
  v_mfma_f32_16x16x32_bf16 v[28:31], v[60:63], v[44:47], v[28:31]
  ds_read_b64 v[64:65], v5 offset:1344
  ds_read_b64 v[66:67], v5 offset:1352
  v_mfma_f32_16x16x32_bf16 v[24:27], v[60:63], v[48:51], v[24:27]
  ds_read_b64 v[84:85], v5 offset:3840
  ds_read_b64 v[86:87], v5 offset:3848
  v_mfma_f32_16x16x32_bf16 v[20:23], v[68:71], v[52:55], v[20:23]
  ds_read_b128 v[80:83], v6 offset:2816
  s_waitcnt lgkmcnt(9)
  v_mfma_f32_16x16x32_bf16 v[16:19], v[68:71], v[44:47], v[16:19]
  ds_read_b128 v[88:91], v6 offset:2304
  v_mfma_f32_16x16x32_bf16 v[28:31], v[68:71], v[48:51], v[28:31]
  ds_read_b128 v[100:103], v6 offset:1792
  v_mfma_f32_16x16x32_bf16 v[24:27], v[68:71], v[56:59], v[24:27]
  ds_read_b128 v[92:95], v6 offset:1280
  s_waitcnt lgkmcnt(10)
  v_mfma_f32_16x16x32_bf16 v[20:23], v[72:75], v[44:47], v[20:23]
  ds_read_b64 v[108:109], v5 offset:3328
  ds_read_b64 v[110:111], v5 offset:3336
  v_mfma_f32_16x16x32_bf16 v[16:19], v[72:75], v[48:51], v[16:19]
  v_mfma_f32_16x16x32_bf16 v[28:31], v[72:75], v[56:59], v[28:31]
  ds_read_b128 v[96:99], v6 offset:768
  s_waitcnt lgkmcnt(9)
  v_mfma_f32_16x16x32_bf16 v[20:23], v[76:79], v[48:51], v[20:23]
  ds_read_b64 v[116:117], v5 offset:2816
  ds_read_b64 v[118:119], v5 offset:2824
  v_mfma_f32_16x16x32_bf16 v[16:19], v[76:79], v[56:59], v[16:19]
  v_mfma_f32_16x16x32_bf16 v[20:23], v[64:67], v[56:59], v[20:23]
  s_waitcnt lgkmcnt(6)
  v_mfma_f32_16x16x32_bf16 v[20:23], v[84:87], v[80:83], v[20:23]
  ds_read_b128 v[104:107], v6 offset:256
  v_mfma_f32_16x16x32_bf16 v[16:19], v[84:87], v[88:91], v[16:19]
  ds_read_b64 v[120:121], v5 offset:2304
  ds_read_b64 v[122:123], v5 offset:2312
  v_mfma_f32_16x16x32_bf16 v[28:31], v[84:87], v[100:103], v[28:31]
  s_waitcnt lgkmcnt(6)
  v_mfma_f32_16x16x32_bf16 v[24:27], v[84:87], v[92:95], v[24:27]
  v_mfma_f32_16x16x32_bf16 v[20:23], v[108:111], v[88:91], v[20:23]
  ds_read_b64 v[124:125], v5 offset:1792
  ds_read_b64 v[126:127], v5 offset:1800
  v_mfma_f32_16x16x32_bf16 v[16:19], v[108:111], v[100:103], v[16:19]
  s_waitcnt lgkmcnt(5)
  v_mfma_f32_16x16x32_bf16 v[28:31], v[108:111], v[92:95], v[28:31]
  ds_read_b64 v[112:113], v5 offset:1280
  ds_read_b64 v[114:115], v5 offset:1288
  v_mfma_f32_16x16x32_bf16 v[24:27], v[108:111], v[96:99], v[24:27]
  ds_read_b64 v[32:33], v5 offset:3776
  ds_read_b64 v[34:35], v5 offset:3784
  v_mfma_f32_16x16x32_bf16 v[20:23], v[116:119], v[100:103], v[20:23]
  ds_read_b128 v[36:39], v6 offset:2752
  s_waitcnt lgkmcnt(9)
  v_mfma_f32_16x16x32_bf16 v[16:19], v[116:119], v[92:95], v[16:19]
  ds_read_b128 v[40:43], v6 offset:2240
  v_mfma_f32_16x16x32_bf16 v[28:31], v[116:119], v[96:99], v[28:31]
  ds_read_b128 v[60:63], v6 offset:1728
  v_mfma_f32_16x16x32_bf16 v[24:27], v[116:119], v[104:107], v[24:27]
  ds_read_b128 v[52:55], v6 offset:1216
  s_waitcnt lgkmcnt(10)
  v_mfma_f32_16x16x32_bf16 v[20:23], v[120:123], v[92:95], v[20:23]
  ds_read_b64 v[68:69], v5 offset:3264
  ds_read_b64 v[70:71], v5 offset:3272
  v_mfma_f32_16x16x32_bf16 v[16:19], v[120:123], v[96:99], v[16:19]
  v_mfma_f32_16x16x32_bf16 v[28:31], v[120:123], v[104:107], v[28:31]
  ds_read_b128 v[44:47], v6 offset:704
  s_waitcnt lgkmcnt(9)
  v_mfma_f32_16x16x32_bf16 v[20:23], v[124:127], v[96:99], v[20:23]
  ds_read_b64 v[72:73], v5 offset:2752
  ds_read_b64 v[74:75], v5 offset:2760
  v_mfma_f32_16x16x32_bf16 v[16:19], v[124:127], v[104:107], v[16:19]
  v_mfma_f32_16x16x32_bf16 v[20:23], v[112:115], v[104:107], v[20:23]
  s_waitcnt lgkmcnt(6)
  v_mfma_f32_16x16x32_bf16 v[20:23], v[32:35], v[36:39], v[20:23]
  ds_read_b128 v[48:51], v6 offset:192
  v_mfma_f32_16x16x32_bf16 v[16:19], v[32:35], v[40:43], v[16:19]
  ds_read_b64 v[76:77], v5 offset:2240
  ds_read_b64 v[78:79], v5 offset:2248
  v_mfma_f32_16x16x32_bf16 v[28:31], v[32:35], v[60:63], v[28:31]
  s_waitcnt lgkmcnt(6)
  v_mfma_f32_16x16x32_bf16 v[24:27], v[32:35], v[52:55], v[24:27]
  v_mfma_f32_16x16x32_bf16 v[20:23], v[68:71], v[40:43], v[20:23]
  ds_read_b64 v[64:65], v5 offset:1728
  ds_read_b64 v[66:67], v5 offset:1736
  v_mfma_f32_16x16x32_bf16 v[16:19], v[68:71], v[60:63], v[16:19]
  s_waitcnt lgkmcnt(5)
  v_mfma_f32_16x16x32_bf16 v[28:31], v[68:71], v[52:55], v[28:31]
  ds_read_b64 v[56:57], v5 offset:1216
  ds_read_b64 v[58:59], v5 offset:1224
  v_mfma_f32_16x16x32_bf16 v[24:27], v[68:71], v[44:47], v[24:27]
  ds_read_b64 v[80:81], v5 offset:3712
  ds_read_b64 v[82:83], v5 offset:3720
  v_mfma_f32_16x16x32_bf16 v[20:23], v[72:75], v[60:63], v[20:23]
  ds_read_b128 v[84:87], v6 offset:2688
  s_waitcnt lgkmcnt(9)
  v_mfma_f32_16x16x32_bf16 v[16:19], v[72:75], v[52:55], v[16:19]
  ds_read_b128 v[88:91], v6 offset:2176
  v_mfma_f32_16x16x32_bf16 v[28:31], v[72:75], v[44:47], v[28:31]
  ds_read_b128 v[108:111], v6 offset:1664
  v_mfma_f32_16x16x32_bf16 v[24:27], v[72:75], v[48:51], v[24:27]
  ds_read_b128 v[100:103], v6 offset:1152
  s_waitcnt lgkmcnt(10)
  v_mfma_f32_16x16x32_bf16 v[20:23], v[76:79], v[52:55], v[20:23]
  ds_read_b64 v[116:117], v5 offset:3200
  ds_read_b64 v[118:119], v5 offset:3208
  v_mfma_f32_16x16x32_bf16 v[16:19], v[76:79], v[44:47], v[16:19]
  v_mfma_f32_16x16x32_bf16 v[28:31], v[76:79], v[48:51], v[28:31]
  ds_read_b128 v[92:95], v6 offset:640
  s_waitcnt lgkmcnt(9)
  v_mfma_f32_16x16x32_bf16 v[20:23], v[64:67], v[44:47], v[20:23]
  ds_read_b64 v[120:121], v5 offset:2688
  ds_read_b64 v[122:123], v5 offset:2696
  v_mfma_f32_16x16x32_bf16 v[16:19], v[64:67], v[48:51], v[16:19]
  v_mfma_f32_16x16x32_bf16 v[20:23], v[56:59], v[48:51], v[20:23]
  s_waitcnt lgkmcnt(6)
  v_mfma_f32_16x16x32_bf16 v[20:23], v[80:83], v[84:87], v[20:23]
  ds_read_b128 v[96:99], v6 offset:128
  v_mfma_f32_16x16x32_bf16 v[16:19], v[80:83], v[88:91], v[16:19]
  ds_read_b64 v[124:125], v5 offset:2176
  ds_read_b64 v[126:127], v5 offset:2184
  v_mfma_f32_16x16x32_bf16 v[28:31], v[80:83], v[108:111], v[28:31]
  s_waitcnt lgkmcnt(6)
  v_mfma_f32_16x16x32_bf16 v[24:27], v[80:83], v[100:103], v[24:27]
  v_mfma_f32_16x16x32_bf16 v[20:23], v[116:119], v[88:91], v[20:23]
  ds_read_b64 v[112:113], v5 offset:1664
  ds_read_b64 v[114:115], v5 offset:1672
  v_mfma_f32_16x16x32_bf16 v[16:19], v[116:119], v[108:111], v[16:19]
  s_waitcnt lgkmcnt(5)
  v_mfma_f32_16x16x32_bf16 v[28:31], v[116:119], v[100:103], v[28:31]
  ds_read_b64 v[104:105], v5 offset:1152
  ds_read_b64 v[106:107], v5 offset:1160
  v_mfma_f32_16x16x32_bf16 v[24:27], v[116:119], v[92:95], v[24:27]
  ds_read_b64 v[36:37], v5 offset:3648
  ds_read_b64 v[38:39], v5 offset:3656
  v_mfma_f32_16x16x32_bf16 v[20:23], v[120:123], v[108:111], v[20:23]
  ds_read_b128 v[32:35], v6 offset:2624
  s_waitcnt lgkmcnt(9)
  v_mfma_f32_16x16x32_bf16 v[16:19], v[120:123], v[100:103], v[16:19]
  ds_read_b128 v[40:43], v6 offset:2112
  v_mfma_f32_16x16x32_bf16 v[28:31], v[120:123], v[92:95], v[28:31]
  ds_read_b128 v[68:71], v6 offset:1600
  v_mfma_f32_16x16x32_bf16 v[24:27], v[120:123], v[96:99], v[24:27]
  ds_read_b128 v[60:63], v6 offset:1088
  s_waitcnt lgkmcnt(10)
  v_mfma_f32_16x16x32_bf16 v[20:23], v[124:127], v[100:103], v[20:23]
  ds_read_b64 v[72:73], v5 offset:3136
  ds_read_b64 v[74:75], v5 offset:3144
  v_mfma_f32_16x16x32_bf16 v[16:19], v[124:127], v[92:95], v[16:19]
  v_mfma_f32_16x16x32_bf16 v[28:31], v[124:127], v[96:99], v[28:31]
  ds_read_b128 v[52:55], v6 offset:576
  s_waitcnt lgkmcnt(9)
  v_mfma_f32_16x16x32_bf16 v[20:23], v[112:115], v[92:95], v[20:23]
  ds_read_b64 v[76:77], v5 offset:2624
  ds_read_b64 v[78:79], v5 offset:2632
  v_mfma_f32_16x16x32_bf16 v[16:19], v[112:115], v[96:99], v[16:19]
  v_mfma_f32_16x16x32_bf16 v[20:23], v[104:107], v[96:99], v[20:23]
  s_waitcnt lgkmcnt(6)
  v_mfma_f32_16x16x32_bf16 v[20:23], v[36:39], v[32:35], v[20:23]
  ds_read_b128 v[44:47], v6 offset:64
  v_mfma_f32_16x16x32_bf16 v[16:19], v[36:39], v[40:43], v[16:19]
  ds_read_b64 v[64:65], v5 offset:2112
  ds_read_b64 v[66:67], v5 offset:2120
  v_mfma_f32_16x16x32_bf16 v[28:31], v[36:39], v[68:71], v[28:31]
  s_waitcnt lgkmcnt(6)
  v_mfma_f32_16x16x32_bf16 v[24:27], v[36:39], v[60:63], v[24:27]
  v_mfma_f32_16x16x32_bf16 v[20:23], v[72:75], v[40:43], v[20:23]
  ds_read_b64 v[56:57], v5 offset:1600
  ds_read_b64 v[58:59], v5 offset:1608
  v_mfma_f32_16x16x32_bf16 v[16:19], v[72:75], v[68:71], v[16:19]
  s_waitcnt lgkmcnt(5)
  v_mfma_f32_16x16x32_bf16 v[28:31], v[72:75], v[60:63], v[28:31]
  ds_read_b64 v[48:49], v5 offset:1088
  ds_read_b64 v[50:51], v5 offset:1096
  v_mfma_f32_16x16x32_bf16 v[24:27], v[72:75], v[52:55], v[24:27]
  ds_read_b64 v[84:85], v5 offset:3584
  ds_read_b64 v[86:87], v5 offset:3592
  v_mfma_f32_16x16x32_bf16 v[20:23], v[76:79], v[68:71], v[20:23]
  ds_read_b128 v[80:83], v6 offset:2560
  s_waitcnt lgkmcnt(9)
  v_mfma_f32_16x16x32_bf16 v[16:19], v[76:79], v[60:63], v[16:19]
  ds_read_b128 v[88:91], v6 offset:2048
  v_mfma_f32_16x16x32_bf16 v[28:31], v[76:79], v[52:55], v[28:31]
  ds_read_b128 v[116:119], v6 offset:1536
  v_mfma_f32_16x16x32_bf16 v[24:27], v[76:79], v[44:47], v[24:27]
  ds_read_b128 v[108:111], v6 offset:1024
  s_waitcnt lgkmcnt(10)
  v_mfma_f32_16x16x32_bf16 v[20:23], v[64:67], v[60:63], v[20:23]
  ds_read_b64 v[120:121], v5 offset:3072
  ds_read_b64 v[122:123], v5 offset:3080
  v_mfma_f32_16x16x32_bf16 v[16:19], v[64:67], v[52:55], v[16:19]
  v_mfma_f32_16x16x32_bf16 v[28:31], v[64:67], v[44:47], v[28:31]
  ds_read_b128 v[100:103], v6 offset:512
  s_waitcnt lgkmcnt(9)
  v_mfma_f32_16x16x32_bf16 v[20:23], v[56:59], v[52:55], v[20:23]
  ds_read_b64 v[124:125], v5 offset:2560
  ds_read_b64 v[126:127], v5 offset:2568
  v_mfma_f32_16x16x32_bf16 v[16:19], v[56:59], v[44:47], v[16:19]
  v_mfma_f32_16x16x32_bf16 v[20:23], v[48:51], v[44:47], v[20:23]
  s_waitcnt lgkmcnt(6)
  v_mfma_f32_16x16x32_bf16 v[20:23], v[84:87], v[80:83], v[20:23]
  ds_read_b128 v[92:95], v6 offset:0
  v_mfma_f32_16x16x32_bf16 v[16:19], v[84:87], v[88:91], v[16:19]
  ds_read_b64 v[112:113], v5 offset:2048
  ds_read_b64 v[114:115], v5 offset:2056
  v_mfma_f32_16x16x32_bf16 v[28:31], v[84:87], v[116:119], v[28:31]
  s_waitcnt lgkmcnt(6)
  v_mfma_f32_16x16x32_bf16 v[24:27], v[84:87], v[108:111], v[24:27]
  v_mfma_f32_16x16x32_bf16 v[20:23], v[120:123], v[88:91], v[20:23]
  ds_read_b64 v[104:105], v5 offset:1536
  ds_read_b64 v[106:107], v5 offset:1544
  v_mfma_f32_16x16x32_bf16 v[16:19], v[120:123], v[116:119], v[16:19]
  s_waitcnt lgkmcnt(5)
  v_mfma_f32_16x16x32_bf16 v[28:31], v[120:123], v[108:111], v[28:31]
  ds_read_b64 v[96:97], v5 offset:1024
  ds_read_b64 v[98:99], v5 offset:1032
  s_mov_b64 exec, 1
  ds_add_u32 v14, v15 offset:49056
  s_mov_b64 exec, -1
  v_mfma_f32_16x16x32_bf16 v[24:27], v[120:123], v[100:103], v[24:27]
  v_mfma_f32_16x16x32_bf16 v[20:23], v[124:127], v[116:119], v[20:23]
  s_waitcnt lgkmcnt(7)
  v_mfma_f32_16x16x32_bf16 v[16:19], v[124:127], v[108:111], v[16:19]
  v_mfma_f32_16x16x32_bf16 v[28:31], v[124:127], v[100:103], v[28:31]
  v_mfma_f32_16x16x32_bf16 v[24:27], v[124:127], v[92:95], v[24:27]
  s_waitcnt lgkmcnt(5)
  v_mfma_f32_16x16x32_bf16 v[20:23], v[112:115], v[108:111], v[20:23]
  v_mfma_f32_16x16x32_bf16 v[16:19], v[112:115], v[100:103], v[16:19]
  v_mfma_f32_16x16x32_bf16 v[28:31], v[112:115], v[92:95], v[28:31]
  s_waitcnt lgkmcnt(1)
  v_mfma_f32_16x16x32_bf16 v[20:23], v[104:107], v[100:103], v[20:23]
  v_mfma_f32_16x16x32_bf16 v[16:19], v[104:107], v[92:95], v[16:19]
  v_mfma_f32_16x16x32_bf16 v[20:23], v[96:99], v[92:95], v[20:23]
L_cv2:
  s_setprio 3
  s_nop 7
  v_cvt_pk_bf16_f32 v48, v16, v17
  v_cvt_pk_bf16_f32 v49, v18, v19
  v_cvt_pk_bf16_f32 v50, v20, v21
  v_cvt_pk_bf16_f32 v51, v22, v23
  s_nop 0
  v_permlane16_swap_b32 v48, v50
  v_permlane16_swap_b32 v49, v51
  buffer_store_dwordx4 v[48:51], v7, s[48:51], s15 offen sc1
  v_cvt_pk_bf16_f32 v52, v24, v25
  v_cvt_pk_bf16_f32 v53, v26, v27
  v_cvt_pk_bf16_f32 v54, v28, v29
  v_cvt_pk_bf16_f32 v55, v30, v31
  s_nop 0
  v_permlane16_swap_b32 v52, v54
  v_permlane16_swap_b32 v53, v55
  buffer_store_dwordx4 v[52:55], v7, s[48:51], s33 offen sc1
L_abl4:
  v_and_b32 v8, 31, v1
  v_lshrrev_b32 v9, 5, v1
  s_waitcnt vmcnt(6)
  v_accvgpr_read_b32 v56, a64
  v_accvgpr_read_b32 v57, a65
  v_accvgpr_read_b32 v58, a66
  v_accvgpr_read_b32 v59, a67
  s_waitcnt vmcnt(5)
  v_accvgpr_read_b32 v60, a68
  v_accvgpr_read_b32 v61, a69
  v_accvgpr_read_b32 v62, a70
  v_accvgpr_read_b32 v63, a71
  s_waitcnt vmcnt(4)
  v_accvgpr_read_b32 v64, a72
  v_accvgpr_read_b32 v65, a73
  v_accvgpr_read_b32 v66, a74
  v_accvgpr_read_b32 v67, a75
  v_lshlrev_b32 v4, 1, v9
  v_sub_u32 v4, v8, v4
  v_mov_b32 v11, 0x3f80
  v_mov_b32 v5, 0x3f800000
  v_cmp_eq_u32 vcc, 0, v4
  v_cmp_eq_u32 s[46:47], 1, v4
  s_nop 0
  v_cndmask_b32 v96, 0, v11, vcc
  v_cndmask_b32 v96, v96, v5, s[46:47]
  v_cmp_eq_u32_e64 vcc, 4, v4
  v_cmp_eq_u32 s[46:47], 5, v4
  s_nop 0
  v_cndmask_b32 v97, 0, v11, vcc
  v_cndmask_b32 v97, v97, v5, s[46:47]
  v_cmp_eq_u32_e64 vcc, 8, v4
  v_cmp_eq_u32 s[46:47], 9, v4
  s_nop 0
  v_cndmask_b32 v98, 0, v11, vcc
  v_cndmask_b32 v98, v98, v5, s[46:47]
  v_cmp_eq_u32_e64 vcc, 12, v4
  v_cmp_eq_u32 s[46:47], 13, v4
  s_nop 0
  v_cndmask_b32 v99, 0, v11, vcc
  v_cndmask_b32 v99, v99, v5, s[46:47]
  v_cmp_eq_u32_e64 vcc, 16, v4
  v_cmp_eq_u32 s[46:47], 17, v4
  s_nop 0
  v_cndmask_b32 v100, 0, v11, vcc
  v_cndmask_b32 v100, v100, v5, s[46:47]
  v_cmp_eq_u32_e64 vcc, 20, v4
  v_cmp_eq_u32 s[46:47], 21, v4
  s_nop 0
  v_cndmask_b32 v101, 0, v11, vcc
  v_cndmask_b32 v101, v101, v5, s[46:47]
  v_cmp_eq_u32_e64 vcc, 24, v4
  v_cmp_eq_u32 s[46:47], 25, v4
  s_nop 0
  v_cndmask_b32 v102, 0, v11, vcc
  v_cndmask_b32 v102, v102, v5, s[46:47]
  v_cmp_eq_u32 vcc, 28, v4
  v_cmp_eq_u32 s[46:47], 29, v4
  s_nop 0
  v_cndmask_b32 v103, 0, v11, vcc
  v_cndmask_b32 v103, v103, v5, s[46:47]
  s_add_u32 s19, s69, 8
  s_bfe_u32 s19, s19, 0x10004
  s_lshl_b32 s20, s7, 1
  s_add_u32 s19, s19, s20
  s_mul_i32 s19, s19, 4352
  s_add_u32 s19, s19, 14753792
  v_lshlrev_b32_e64 v11, 7, v8
  v_lshl_add_u32 v11, v9, 4, v11
  s_mul_i32 s73, s69, 57344
  s_lshl_b32 s20, s7, 13
  s_add_u32 s73, s73, s20
  s_lshl_b32 s20, s9, 6
  s_add_u32 s73, s73, s20
  s_lshl_b32 s20, s8, 5
  s_add_u32 s73, s73, s20
  s_add_u32 s73, s73, 4194304
  s_add_u32 s34, s73, 4096
  v_and_b32_e64 v2, 15, v1
  v_bfe_u32 v4, v1, 4, 1
  v_lshlrev_b32 v4, 2, v4
  v_and_b32 v10, 7, v1
  v_xor_b32 v4, v4, v10
  v_lshlrev_b32 v4, 4, v4
  v_lshl_add_u32 v4, v2, 7, v4
  v_lshl_add_u32 v4, v9, 3, v4
  s_lshl_b32 s20, s3, 11
  v_add_u32 v2, s20, v4
  v_lshrrev_b32 v9, 3, v1
  v_lshlrev_b32 v4, 4, v9
  v_xor_b32_e64 v4, v4, v3
  v_add_u32 v4, s20, v4
  s_cmp_eq_u32 s8, 0
  s_movk_i32 s20, 16384
  s_cselect_b32 s20, s20, 28672
  s_movk_i32 s21, 4096
  s_cselect_b32 s21, s21, 7168
  s_cselect_b32 s25, 0, 49152
  s_lshl_b32 s24, s9, 8
  s_add_u32 s25, s25, s24
  v_lshlrev_b32 v8, 1, v10
  v_xor_b32 v8, v8, v9
  v_lshlrev_b32 v8, 4, v8
  v_and_b32 v5, 3, v1
  v_lshl_add_u32 v8, v5, 10, v8
  v_bfe_u32 v5, v1, 2, 1
  v_mul_lo_u32 v5, v5, s20
  v_add3_u32 v5, v5, v8, s25
  v_add_u32 v6, s21, v5
  v_add_u32 v7, s21, v6
  v_add_u32_e64 v8, s21, v7
  s_waitcnt vmcnt(0)
  s_mov_b32 s91, 1
  s_buffer_atomic_add s91, s[48:51], s26
  v_lshlrev_b32 v112, 16, v56
  v_and_b32 v113, s14, v56
  v_lshlrev_b32 v16, 16, v64
  v_and_b32 v17, s14, v64
  v_add_f32 v112, v112, v16
  v_add_f32 v113, v113, v17
  v_lshlrev_b32 v114, 16, v57
  v_and_b32 v115, s14, v57
  v_lshlrev_b32 v16, 16, v65
  v_and_b32 v17, s14, v65
  v_add_f32 v114, v114, v16
  v_add_f32 v115, v115, v17
  v_lshlrev_b32 v116, 16, v58
  v_and_b32 v117, s14, v58
  v_lshlrev_b32 v16, 16, v66
  v_and_b32 v17, s14, v66
  v_add_f32 v116, v116, v16
  v_add_f32 v117, v117, v17
  v_lshlrev_b32 v118, 16, v59
  v_and_b32 v119, s14, v59
  v_lshlrev_b32 v16, 16, v67
  v_and_b32 v17, s14, v67
  v_add_f32 v118, v118, v16
  v_add_f32 v119, v119, v17
  v_lshlrev_b32 v120, 16, v60
  v_and_b32 v121, s14, v60
  v_lshlrev_b32 v16, 16, v64
  v_and_b32 v17, s14, v64
  v_add_f32 v120, v120, v16
  v_add_f32 v121, v121, v17
  v_lshlrev_b32 v122, 16, v61
  v_and_b32 v123, s14, v61
  v_lshlrev_b32 v16, 16, v65
  v_and_b32 v17, s14, v65
  v_add_f32 v122, v122, v16
  v_add_f32 v123, v123, v17
  v_lshlrev_b32 v124, 16, v62
  v_and_b32 v125, s14, v62
  v_lshlrev_b32 v16, 16, v66
  v_and_b32 v17, s14, v66
  v_add_f32 v124, v124, v16
  v_add_f32 v125, v125, v17
  v_lshlrev_b32 v126, 16, v63
  v_and_b32 v127, s14, v63
  v_lshlrev_b32 v16, 16, v67
  v_and_b32 v17, s14, v67
  v_add_f32 v126, v126, v16
  v_add_f32 v127, v127, v17
  v_xor_b32 v72, 128, v5
  v_xor_b32 v73, 128, v6
  v_xor_b32 v74, 128, v7
  v_xor_b32 v75, 128, v8
  v_accvgpr_read_b32 v76, a76
  v_and_b32 v76, s14, v76
  v_rcp_f32 v76, v76
  v_accvgpr_read_b32 v78, a77
  v_and_b32 v78, s14, v78
  v_rcp_f32 v78, v78
  v_mul_f32 v76, v76, v76
  v_mul_f32 v78, v78, v78
  ds_read_b32 v9, v14 offset:49068
  ds_read_b32 a120, v14
  s_waitcnt lgkmcnt(1)
  v_cmp_gt_u32 vcc, 1, v9
  s_nop 0
  s_cbranch_vccz COK_61
  s_mov_b32 s66, 0x2000000
CLP_62:
  s_sleep 4
  ds_read_b32 v9, v14 offset:49068
  s_waitcnt lgkmcnt(0)
  v_cmp_gt_u32 vcc, 1, v9
  s_sub_u32 s66, s66, 1
  s_cbranch_scc1 COK_61
  s_cbranch_vccnz CLP_62
COK_61:
  ds_read_b32 v9, v14 offset:49056
  ds_read_b32 a120, v14
  s_waitcnt lgkmcnt(1)
  v_cmp_gt_u32 vcc, 4, v9
  s_nop 0
  s_cbranch_vccz COK_64
  s_mov_b32 s66, 0x2000000
CLP_65:
  s_sleep 2
  ds_read_b32 v9, v14 offset:49056
  s_waitcnt lgkmcnt(0)
  v_cmp_gt_u32 vcc, 4, v9
  s_sub_u32 s66, s66, 1
  s_cbranch_scc1 COK_64
  s_cbranch_vccnz CLP_65
COK_64:
  s_cmp_lg_u32 s3, 0
  s_cbranch_scc1 L_noy
  s_buffer_load_dword s76, s[48:51], s19 glc
  s_waitcnt lgkmcnt(0)
  s_sub_u32 s76, s76, s64
  s_cmp_eq_u32 s76, 64
  s_cbranch_scc1 KOK_67
  s_mov_b32 s66, 0x100000
KLP_68:
  s_sleep 8
  s_buffer_load_dword s76, s[48:51], s19 glc
  s_waitcnt lgkmcnt(0)
  s_sub_u32 s76, s76, s64
  s_cmp_eq_u32 s76, 64
  s_cbranch_scc1 KOK_67
  s_sub_u32 s66, s66, 1
  s_cbranch_scc0 KLP_68
KOK_67:
  s_mov_b64 exec, 1
  ds_add_u32 v14, v15 offset:49072
  s_mov_b64 exec, -1
L_noy:
  ds_read_b32 v9, v14 offset:49072
  s_waitcnt lgkmcnt(0)
  v_cmp_gt_u32 vcc, 1, v9
  s_nop 0
  s_cbranch_vccz COK_70
  s_mov_b32 s66, 0x2000000
CLP_71:
  s_sleep 1
  ds_read_b32 v9, v14 offset:49072
  s_waitcnt lgkmcnt(0)
  v_cmp_gt_u32 vcc, 1, v9
  s_sub_u32 s66, s66, 1
  s_cbranch_scc1 COK_70
  s_cbranch_vccnz CLP_71
COK_70:
  buffer_load_dwordx4 v[104:107], v11, s[48:51], s73 offen sc1
  buffer_load_dwordx4 v[108:111], v11, s[48:51], s34 offen sc1
  s_waitcnt vmcnt(1)
  v_mfma_f32_32x32x16_bf16 v[80:95], v[104:107], v[96:99], 0
  s_waitcnt vmcnt(0)
  v_mfma_f32_32x32x16_bf16 v[80:95], v[108:111], v[100:103], v[80:95]
  s_nop 11
  v_cvt_pk_bf16_f32 v16, v80, v81
  v_cvt_pk_bf16_f32 v17, v82, v83
  ds_write_b64 v2, v[16:17] offset:32768
  v_cvt_pk_bf16_f32 v18, v84, v85
  v_cvt_pk_bf16_f32 v19, v86, v87
  v_xor_b32_e64 v25, 16, v2
  ds_write_b64 v25, v[18:19] offset:32768
  v_cvt_pk_bf16_f32 v20, v88, v89
  v_cvt_pk_bf16_f32 v21, v90, v91
  v_xor_b32_e64 v26, 32, v2
  ds_write_b64 v26, v[20:21] offset:32768
  v_cvt_pk_bf16_f32 v22, v92, v93
  v_cvt_pk_bf16_f32 v23, v94, v95
  v_xor_b32_e64 v27, 48, v2
  ds_write_b64 v27, v[22:23] offset:32768
  ds_read_b128 v[32:35], v4 offset:32768
  ds_read_b128 v[36:39], v4 offset:33792
  s_waitcnt lgkmcnt(1)
  v_lshlrev_b32 v16, 16, v32
  v_and_b32 v17, s14, v32
  v_add_f32 v112, v112, v16
  v_add_f32 v113, v113, v17
  v_lshlrev_b32 v16, 16, v33
  v_and_b32 v17, s14, v33
  v_add_f32 v114, v114, v16
  v_add_f32 v115, v115, v17
  v_lshlrev_b32 v16, 16, v34
  v_and_b32 v17, s14, v34
  v_add_f32 v116, v116, v16
  v_add_f32 v117, v117, v17
  v_lshlrev_b32 v16, 16, v35
  v_and_b32 v17, s14, v35
  v_add_f32 v118, v118, v16
  v_add_f32 v119, v119, v17
  s_waitcnt lgkmcnt(0)
  v_lshlrev_b32 v16, 16, v36
  v_and_b32 v17, s14, v36
  v_add_f32 v120, v120, v16
  v_add_f32 v121, v121, v17
  v_lshlrev_b32 v16, 16, v37
  v_and_b32 v17, s14, v37
  v_add_f32 v122, v122, v16
  v_add_f32 v123, v123, v17
  v_lshlrev_b32 v16, 16, v38
  v_and_b32 v17, s14, v38
  v_add_f32 v124, v124, v16
  v_add_f32 v125, v125, v17
  v_lshlrev_b32 v16, 16, v39
  v_and_b32 v17, s14, v39
  v_add_f32_e64 v126, v126, v16
  v_add_f32 v127, v127, v17
  s_barrier
  ds_read_b128 v[16:19], v5 offset:0
  ds_read_b128 v[20:23], v5 offset:512
  ds_read_b128 v[24:27], v6 offset:0
  ds_read_b128 v[28:31], v6 offset:512
  ds_read_b128 v[32:35], v7 offset:0
  ds_read_b128 v[36:39], v7 offset:512
  ds_read_b128 v[40:43], v8 offset:0
  ds_read_b128 v[44:47], v8 offset:512
  ds_read_b128 v[80:83], v72 offset:0
  ds_read_b128 v[84:87], v72 offset:512
  ds_read_b128 v[88:91], v73 offset:0
  ds_read_b128 v[92:95], v73 offset:512
  ds_read_b128 v[96:99], v74 offset:0
  ds_read_b128 v[100:103], v74 offset:512
  ds_read_b128 v[104:107], v75 offset:0
  ds_read_b128 v[108:111], v75 offset:512
  s_waitcnt lgkmcnt(13)
  v_pk_add_f32 v[16:17], v[16:17], v[24:25]
  v_pk_add_f32 v[18:19], v[18:19], v[26:27]
  s_waitcnt lgkmcnt(12)
  v_pk_add_f32 v[20:21], v[20:21], v[28:29]
  v_pk_add_f32 v[22:23], v[22:23], v[30:31]
  s_waitcnt lgkmcnt(11)
  v_pk_add_f32 v[16:17], v[16:17], v[32:33]
  v_pk_add_f32 v[18:19], v[18:19], v[34:35]
  s_waitcnt lgkmcnt(10)
  v_pk_add_f32 v[20:21], v[20:21], v[36:37]
  v_pk_add_f32 v[22:23], v[22:23], v[38:39]
  s_waitcnt lgkmcnt(9)
  v_pk_add_f32 v[16:17], v[16:17], v[40:41]
  v_pk_fma_f32 v[112:113], v[16:17], v[76:77], v[112:113] op_sel_hi:[1,0,1]
  v_cvt_pk_bf16_f32 v48, v112, v113
  v_pk_add_f32 v[18:19], v[18:19], v[42:43]
  v_pk_fma_f32 v[114:115], v[18:19], v[76:77], v[114:115] op_sel_hi:[1,0,1]
  v_cvt_pk_bf16_f32 v49, v114, v115
  s_waitcnt lgkmcnt(8)
  v_pk_add_f32 v[20:21], v[20:21], v[44:45]
  v_pk_fma_f32 v[116:117], v[20:21], v[76:77], v[116:117] op_sel_hi:[1,0,1]
  v_cvt_pk_bf16_f32 v50, v116, v117
  v_pk_add_f32 v[22:23], v[22:23], v[46:47]
  v_pk_fma_f32 v[118:119], v[22:23], v[76:77], v[118:119] op_sel_hi:[1,0,1]
  v_cvt_pk_bf16_f32 v51, v118, v119
  buffer_store_dwordx4 v[48:51], v13, s[60:63], s74 offen sc1
  s_waitcnt lgkmcnt(5)
  v_pk_add_f32 v[80:81], v[80:81], v[88:89]
  v_pk_add_f32 v[82:83], v[82:83], v[90:91]
  s_waitcnt lgkmcnt(4)
  v_pk_add_f32 v[84:85], v[84:85], v[92:93]
  v_pk_add_f32 v[86:87], v[86:87], v[94:95]
  s_waitcnt lgkmcnt(3)
  v_pk_add_f32 v[80:81], v[80:81], v[96:97]
  v_pk_add_f32 v[82:83], v[82:83], v[98:99]
  s_waitcnt lgkmcnt(2)
  v_pk_add_f32 v[84:85], v[84:85], v[100:101]
  v_pk_add_f32 v[86:87], v[86:87], v[102:103]
  s_waitcnt lgkmcnt(1)
  v_pk_add_f32 v[80:81], v[80:81], v[104:105]
  v_pk_fma_f32 v[120:121], v[80:81], v[78:79], v[120:121] op_sel_hi:[1,0,1]
  v_cvt_pk_bf16_f32 v52, v120, v121
  v_pk_add_f32 v[82:83], v[82:83], v[106:107]
  v_pk_fma_f32 v[122:123], v[82:83], v[78:79], v[122:123] op_sel_hi:[1,0,1]
  v_cvt_pk_bf16_f32 v53, v122, v123
  s_waitcnt lgkmcnt(0)
  v_pk_add_f32 v[84:85], v[84:85], v[108:109]
  v_pk_fma_f32 v[124:125], v[84:85], v[78:79], v[124:125] op_sel_hi:[1,0,1]
  v_cvt_pk_bf16_f32 v54, v124, v125
  v_pk_add_f32 v[86:87], v[86:87], v[110:111]
  v_pk_fma_f32 v[126:127], v[86:87], v[78:79], v[126:127] op_sel_hi:[1,0,1]
  v_cvt_pk_bf16_f32 v55, v126, v127
  buffer_store_dwordx4 v[52:55], v13, s[60:63], s75 offen sc1
  s_branch L_fin
.p2align 6
L_sp_body:
  s_mov_b32 s56, s40
  s_mov_b32 s57, s41
  s_mul_i32 s75, s74, 7488
  s_add_u32 s75, s75, 49152
  v_mul_u32_u24 v10, 912, v5
  v_lshl_add_u32 v10, v6, 4, v10
  v_add_u32 v10, s75, v10
  v_lshrrev_b32 v4, 4, v1
  v_bfe_u32 v2, v1, 1, 1
  v_lshl_add_u32 v4, v4, 1, v2
  v_bfe_u32 v7, v1, 2, 2
  v_mul_u32_u24 v7, 912, v7
  v_mul_u32_u24 v4, 7488, v4
  v_add_u32 v7, v7, v4
  v_and_b32 v8, 1, v1
  v_lshl_add_u32 v7, v8, 3, v7
  s_lshl_b32 s15, s74, 4
  s_add_u32 s15, s15, 49152
  v_add_u32 v7, s15, v7
  v_xor_b32_e64 v2, v5, v6
  v_lshlrev_b32 v2, 4, v2
  s_lshl_b32 s15, s74, 12
  s_add_u32 s15, s15, 109312
  v_add_u32 v2, s15, v2
  s_waitcnt vmcnt(8)
  v_lshl_add_u32 v11, v6, 7, v2
  v_lshl_add_u32 v4, v5, 7, v2
  v_mul_u32_u24 v8, 4224, v5
  v_lshl_add_u32 v8, v6, 4, v8
  s_mul_i32 s75, s74, 33792
  s_lshl_b32 s15, s9, 7
  s_add_u32 s75, s75, s15
  s_add_u32 s75, s75, 4096
  s_lshl_b32 s73, s8, 6
  s_add_u32 s73, s73, 14876672
  v_lshlrev_b32_e64 v9, 3, v5
  s_lshl_b32 s9, s9, 2
  s_mul_i32 s10, s74, 17408
  s_add_u32 s9, s9, s10
  s_add_u32 s9, s9, 14942208
  s_lshr_b32 s15, s8, 3
  s_mul_i32 s15, s15, 118272
  s_add_u32 s15, s15, 4092
  s_and_b32 s10, s8, 0x87
  s_cmp_eq_u32 s10, 0
  s_cselect_b32 s15, s15, s50
  v_min_u32_e64 v2, 27, v1
  v_mul_u32_u24 v2, 4224, v2
  buffer_store_dword v14, v2, s[48:51], s15 offen sc1
  s_setprio 2
  s_waitcnt vmcnt(8)
  v_add_u32 v12, 0x9e3779b9, v12
  s_nop 0
  v_readfirstlane_b32 s64, v12
  v_readfirstlane_b32 s65, v12
  s_lshr_b32 s12, s8, 4
  s_and_b32 s13, s8, 15
  s_lshl_b32 s15, s12, 3
  s_add_u32 s15, s15, s13
  s_lshl_b32 s15, s15, 7
  s_add_u32 s15, s15, 14721024
  s_mul_i32 s12, s12, 4352
  s_add_u32 s12, s12, 14753792
  s_cmp_eq_u32 s13, 8
  s_cselect_b32 s15, s12, s15
  s_cmp_gt_u32 s13, 8
  s_cbranch_scc1 L_noinit
  s_mov_b32 s76, s64
  s_buffer_atomic_swap s76, s[48:51], s15 glc
L_noinit:
  v_mov_b32 v112, 0
  v_mov_b32 v113, 0
  v_mov_b32 v114, 0x3f803f80
  s_waitcnt vmcnt(7)
  v_dot2_f32_bf16 v112, v16, v114, v112
  v_dot2_f32_bf16 v113, v16, v16, v113
  v_dot2_f32_bf16 v112, v17, v114, v112
  v_dot2_f32_bf16 v113, v17, v17, v113
  v_dot2_f32_bf16 v112, v18, v114, v112
  v_dot2_f32_bf16 v113, v18, v18, v113
  v_dot2_f32_bf16 v112, v19, v114, v112
  v_dot2_f32_bf16 v113, v19, v19, v113
  s_waitcnt vmcnt(6)
  s_nop 0
  v_dot2_f32_bf16 v112, v20, v114, v112
  v_dot2_f32_bf16 v113, v20, v20, v113
  v_dot2_f32_bf16 v112, v21, v114, v112
  v_dot2_f32_bf16 v113, v21, v21, v113
  v_dot2_f32_bf16 v112, v22, v114, v112
  v_dot2_f32_bf16 v113, v22, v22, v113
  v_dot2_f32_bf16 v112, v23, v114, v112
  v_dot2_f32_bf16 v113, v23, v23, v113
  s_waitcnt vmcnt(5)
  v_dot2_f32_bf16 v112, v24, v114, v112
  v_dot2_f32_bf16 v113, v24, v24, v113
  v_dot2_f32_bf16 v112, v25, v114, v112
  v_dot2_f32_bf16 v113, v25, v25, v113
  v_dot2_f32_bf16 v112, v26, v114, v112
  v_dot2_f32_bf16 v113, v26, v26, v113
  v_dot2_f32_bf16 v112, v27, v114, v112
  v_dot2_f32_bf16 v113, v27, v27, v113
  s_waitcnt vmcnt(4)
  v_dot2_f32_bf16 v112, v28, v114, v112
  v_dot2_f32_bf16 v113, v28, v28, v113
  v_dot2_f32_bf16 v112, v29, v114, v112
  v_dot2_f32_bf16 v113, v29, v29, v113
  v_dot2_f32_bf16 v112, v30, v114, v112
  v_dot2_f32_bf16 v113, v30, v30, v113
  v_dot2_f32_bf16 v112, v31, v114, v112
  v_dot2_f32_bf16 v113, v31, v31, v113
  s_waitcnt vmcnt(3)
  v_dot2_f32_bf16 v112, v32, v114, v112
  v_dot2_f32_bf16 v113, v32, v32, v113
  v_dot2_f32_bf16 v112, v33, v114, v112
  v_dot2_f32_bf16 v113, v33, v33, v113
  v_dot2_f32_bf16 v112, v34, v114, v112
  v_dot2_f32_bf16 v113, v34, v34, v113
  v_dot2_f32_bf16 v112, v35, v114, v112
  v_dot2_f32_bf16 v113, v35, v35, v113
  s_waitcnt vmcnt(2)
  v_dot2_f32_bf16 v112, v36, v114, v112
  v_dot2_f32_bf16 v113, v36, v36, v113
  v_dot2_f32_bf16 v112, v37, v114, v112
  v_dot2_f32_bf16 v113, v37, v37, v113
  v_dot2_f32_bf16 v112, v38, v114, v112
  v_dot2_f32_bf16 v113, v38, v38, v113
  v_dot2_f32_bf16 v112, v39, v114, v112
  v_dot2_f32_bf16 v113, v39, v39, v113
  s_waitcnt vmcnt(1)
  v_dot2_f32_bf16 v112, v40, v114, v112
  v_dot2_f32_bf16 v113, v40, v40, v113
  v_dot2_f32_bf16 v112, v41, v114, v112
  v_dot2_f32_bf16 v113, v41, v41, v113
  v_dot2_f32_bf16 v112, v42, v114, v112
  v_dot2_f32_bf16 v113, v42, v42, v113
  v_dot2_f32_bf16 v112, v43, v114, v112
  v_dot2_f32_bf16 v113, v43, v43, v113
  s_nop 1
  v_add_f32_dpp v112, v112, v112 quad_perm:[1,0,3,2] row_mask:0xf bank_mask:0xf
  v_add_f32_dpp v113, v113, v113 quad_perm:[1,0,3,2] row_mask:0xf bank_mask:0xf
  s_nop 0
  v_add_f32_dpp v112, v112, v112 quad_perm:[2,3,0,1] row_mask:0xf bank_mask:0xf
  v_add_f32_dpp v113, v113, v113 quad_perm:[2,3,0,1] row_mask:0xf bank_mask:0xf
  s_nop 0
  v_add_f32_dpp v112, v112, v112 row_half_mirror row_mask:0xf bank_mask:0xf
  v_add_f32_dpp v113, v113, v113 row_half_mirror row_mask:0xf bank_mask:0xf
  v_mul_f32 v116, 0x3b124925, v112
  v_mul_f32 v120, 0x3b124925, v113
  v_fma_f32 v120, -v116, v116, v120
  v_max_f32_e64 v120, 0, v120
  v_cvt_pk_bf16_f32 v116, 0, v116
  v_cvt_pk_bf16_f32 v120, 0, v120
  v_add_f32 v120, 0x3727c5ac, v120
  v_cvt_pk_bf16_f32 v120, 0, v120
  v_sqrt_f32 v120, v120
  s_waitcnt lgkmcnt(0)
  v_cvt_pk_bf16_f32 v122, -v116, v120
  v_mov_b32_e64 v123, v12
  v_cvt_pk_bf16_f32 v120, 0, v120
  s_mov_b32 exec_lo, 0x01010101
  s_mov_b32 exec_hi, 0x01010101
  buffer_store_dwordx2 v[122:123], v9, s[48:51], s73 offen sc1
  s_mov_b64 exec, -1
  v_rcp_f32 v120, v120
  v_min_u32 v13, 48, v1
  v_lshlrev_b32 v13, 7, v13
  s_mul_i32 s15, s8, 6272
  buffer_load_dword v13, v13, s[56:59], s15 offen
  v_mul_f32 v116, -v116, v120
  v_lshlrev_b32 v104, 16, v16
  v_and_b32 v105, s14, v16
  v_pk_fma_f32 v[104:105], v[104:105], v[120:121], v[116:117] op_sel_hi:[1,0,0]
  v_cvt_pk_bf16_f32 v16, v104, v105
  v_lshlrev_b32 v106, 16, v17
  v_and_b32 v107, s14, v17
  v_pk_fma_f32 v[106:107], v[106:107], v[120:121], v[116:117] op_sel_hi:[1,0,0]
  v_cvt_pk_bf16_f32 v17, v106, v107
  v_lshlrev_b32 v104, 16, v18
  v_and_b32 v105, s14, v18
  v_pk_fma_f32 v[104:105], v[104:105], v[120:121], v[116:117] op_sel_hi:[1,0,0]
  v_cvt_pk_bf16_f32 v18, v104, v105
  v_lshlrev_b32 v106, 16, v19
  v_and_b32 v107, s14, v19
  v_pk_fma_f32 v[106:107], v[106:107], v[120:121], v[116:117] op_sel_hi:[1,0,0]
  v_cvt_pk_bf16_f32 v19, v106, v107
  ds_write_b128 v10, v[16:19] offset:0
  v_lshlrev_b32 v104, 16, v20
  v_and_b32 v105, s14, v20
  v_pk_fma_f32 v[104:105], v[104:105], v[120:121], v[116:117] op_sel_hi:[1,0,0]
  v_cvt_pk_bf16_f32 v20, v104, v105
  v_lshlrev_b32 v106, 16, v21
  v_and_b32 v107, s14, v21
  v_pk_fma_f32 v[106:107], v[106:107], v[120:121], v[116:117] op_sel_hi:[1,0,0]
  v_cvt_pk_bf16_f32 v21, v106, v107
  v_lshlrev_b32 v104, 16, v22
  v_and_b32 v105, s14, v22
  v_pk_fma_f32 v[104:105], v[104:105], v[120:121], v[116:117] op_sel_hi:[1,0,0]
  v_cvt_pk_bf16_f32 v22, v104, v105
  v_lshlrev_b32 v106, 16, v23
  v_and_b32 v107, s14, v23
  v_pk_fma_f32 v[106:107], v[106:107], v[120:121], v[116:117] op_sel_hi:[1,0,0]
  v_cvt_pk_bf16_f32 v23, v106, v107
  ds_write_b128 v10, v[20:23] offset:128
  v_lshlrev_b32 v104, 16, v24
  v_and_b32 v105, s14, v24
  v_pk_fma_f32 v[104:105], v[104:105], v[120:121], v[116:117] op_sel_hi:[1,0,0]
  v_cvt_pk_bf16_f32 v24, v104, v105
  v_lshlrev_b32 v106, 16, v25
  v_and_b32 v107, s14, v25
  v_pk_fma_f32 v[106:107], v[106:107], v[120:121], v[116:117] op_sel_hi:[1,0,0]
  v_cvt_pk_bf16_f32 v25, v106, v107
  v_lshlrev_b32 v104, 16, v26
  v_and_b32 v105, s14, v26
  v_pk_fma_f32 v[104:105], v[104:105], v[120:121], v[116:117] op_sel_hi:[1,0,0]
  v_cvt_pk_bf16_f32 v26, v104, v105
  v_lshlrev_b32 v106, 16, v27
  v_and_b32 v107, s14, v27
  v_pk_fma_f32 v[106:107], v[106:107], v[120:121], v[116:117] op_sel_hi:[1,0,0]
  v_cvt_pk_bf16_f32 v27, v106, v107
  ds_write_b128 v10, v[24:27] offset:256
  v_lshlrev_b32 v104, 16, v28
  v_and_b32 v105, s14, v28
  v_pk_fma_f32 v[104:105], v[104:105], v[120:121], v[116:117] op_sel_hi:[1,0,0]
  v_cvt_pk_bf16_f32 v28, v104, v105
  v_lshlrev_b32 v106, 16, v29
  v_and_b32 v107, s14, v29
  v_pk_fma_f32 v[106:107], v[106:107], v[120:121], v[116:117] op_sel_hi:[1,0,0]
  v_cvt_pk_bf16_f32 v29, v106, v107
  v_lshlrev_b32 v104, 16, v30
  v_and_b32 v105, s14, v30
  v_pk_fma_f32 v[104:105], v[104:105], v[120:121], v[116:117] op_sel_hi:[1,0,0]
  v_cvt_pk_bf16_f32 v30, v104, v105
  v_lshlrev_b32 v106, 16, v31
  v_and_b32 v107, s14, v31
  v_pk_fma_f32 v[106:107], v[106:107], v[120:121], v[116:117] op_sel_hi:[1,0,0]
  v_cvt_pk_bf16_f32 v31, v106, v107
  ds_write_b128 v10, v[28:31] offset:384
  v_lshlrev_b32 v104, 16, v32
  v_and_b32 v105, s14, v32
  v_pk_fma_f32 v[104:105], v[104:105], v[120:121], v[116:117] op_sel_hi:[1,0,0]
  v_cvt_pk_bf16_f32 v32, v104, v105
  v_lshlrev_b32 v106, 16, v33
  v_and_b32 v107, s14, v33
  v_pk_fma_f32 v[106:107], v[106:107], v[120:121], v[116:117] op_sel_hi:[1,0,0]
  v_cvt_pk_bf16_f32 v33, v106, v107
  v_lshlrev_b32 v104, 16, v34
  v_and_b32 v105, s14, v34
  v_pk_fma_f32 v[104:105], v[104:105], v[120:121], v[116:117] op_sel_hi:[1,0,0]
  v_cvt_pk_bf16_f32 v34, v104, v105
  v_lshlrev_b32 v106, 16, v35
  v_and_b32 v107, s14, v35
  v_pk_fma_f32 v[106:107], v[106:107], v[120:121], v[116:117] op_sel_hi:[1,0,0]
  v_cvt_pk_bf16_f32 v35, v106, v107
  ds_write_b128 v10, v[32:35] offset:512
  v_lshlrev_b32 v104, 16, v36
  v_and_b32 v105, s14, v36
  v_pk_fma_f32 v[104:105], v[104:105], v[120:121], v[116:117] op_sel_hi:[1,0,0]
  v_cvt_pk_bf16_f32 v36, v104, v105
  v_lshlrev_b32 v106, 16, v37
  v_and_b32 v107, s14, v37
  v_pk_fma_f32 v[106:107], v[106:107], v[120:121], v[116:117] op_sel_hi:[1,0,0]
  v_cvt_pk_bf16_f32 v37, v106, v107
  v_lshlrev_b32 v104, 16, v38
  v_and_b32 v105, s14, v38
  v_pk_fma_f32 v[104:105], v[104:105], v[120:121], v[116:117] op_sel_hi:[1,0,0]
  v_cvt_pk_bf16_f32 v38, v104, v105
  v_lshlrev_b32 v106, 16, v39
  v_and_b32 v107, s14, v39
  v_pk_fma_f32 v[106:107], v[106:107], v[120:121], v[116:117] op_sel_hi:[1,0,0]
  v_cvt_pk_bf16_f32 v39, v106, v107
  ds_write_b128 v10, v[36:39] offset:640
  v_lshlrev_b32 v104, 16, v40
  v_and_b32 v105, s14, v40
  v_pk_fma_f32 v[104:105], v[104:105], v[120:121], v[116:117] op_sel_hi:[1,0,0]
  v_cvt_pk_bf16_f32 v40, v104, v105
  v_lshlrev_b32 v106, 16, v41
  v_and_b32 v107, s14, v41
  v_pk_fma_f32 v[106:107], v[106:107], v[120:121], v[116:117] op_sel_hi:[1,0,0]
  v_cvt_pk_bf16_f32 v41, v106, v107
  v_lshlrev_b32 v104, 16, v42
  v_and_b32 v105, s14, v42
  v_pk_fma_f32 v[104:105], v[104:105], v[120:121], v[116:117] op_sel_hi:[1,0,0]
  v_cvt_pk_bf16_f32 v42, v104, v105
  v_lshlrev_b32 v106, 16, v43
  v_and_b32 v107, s14, v43
  v_pk_fma_f32 v[106:107], v[106:107], v[120:121], v[116:117] op_sel_hi:[1,0,0]
  v_cvt_pk_bf16_f32 v43, v106, v107
  ds_write_b128 v10, v[40:43] offset:768
  s_waitcnt lgkmcnt(0)
  s_barrier
  ds_read_b64_tr_b16 v[48:49], v7 offset:0
  ds_read_b64_tr_b16 v[50:51], v7 offset:3648
  ds_read_b64_tr_b16 v[52:53], v7 offset:128
  ds_read_b64_tr_b16 v[54:55], v7 offset:3776
  ds_read_b64_tr_b16 v[56:57], v7 offset:256
  ds_read_b64_tr_b16 v[58:59], v7 offset:3904
  ds_read_b64_tr_b16 v[60:61], v7 offset:384
  ds_read_b64_tr_b16 v[62:63], v7 offset:4032
  ds_read_b64_tr_b16 v[64:65], v7 offset:512
  ds_read_b64_tr_b16 v[66:67], v7 offset:4160
  ds_read_b64_tr_b16 v[68:69], v7 offset:640
  ds_read_b64_tr_b16 v[70:71], v7 offset:4288
  ds_read_b64_tr_b16 v[72:73], v7 offset:768
  ds_read_b64_tr_b16 v[74:75], v7 offset:4416
  s_waitcnt lgkmcnt(12)
  ds_write_b128 v11, v[48:51] offset:0
  ds_read_b128 v[16:19], v4 offset:0
  s_waitcnt lgkmcnt(12)
  ds_write_b128 v11, v[52:55] offset:1024
  ds_read_b128 v[20:23], v4 offset:1024
  s_waitcnt lgkmcnt(12)
  ds_write_b128 v11, v[56:59] offset:2048
  ds_read_b128 v[24:27], v4 offset:2048
  s_waitcnt lgkmcnt(12)
  ds_write_b128 v11, v[60:63] offset:3072
  ds_read_b128 v[28:31], v4 offset:3072
  s_waitcnt lgkmcnt(12)
  ds_write_b128 v11, v[64:67] offset:0
  ds_read_b128 v[32:35], v4 offset:0
  s_waitcnt lgkmcnt(12)
  ds_write_b128 v11, v[68:71] offset:1024
  ds_read_b128 v[36:39], v4 offset:1024
  s_waitcnt lgkmcnt(12)
  ds_write_b128 v11, v[72:75] offset:2048
  ds_read_b128 v[40:43], v4 offset:2048
  s_waitcnt lgkmcnt(12)
  buffer_store_dwordx4 v[16:19], v8, s[48:51], s75 offen sc1
  s_add_u32 s75, s75, 270336
  s_waitcnt lgkmcnt(10)
  buffer_store_dwordx4 v[20:23], v8, s[48:51], s75 offen sc1
  s_add_u32 s75, s75, 270336
  s_waitcnt lgkmcnt(8)
  buffer_store_dwordx4 v[24:27], v8, s[48:51], s75 offen sc1
  s_add_u32 s75, s75, 270336
  s_waitcnt lgkmcnt(6)
  buffer_store_dwordx4 v[28:31], v8, s[48:51], s75 offen sc1
  s_add_u32 s75, s75, 270336
  s_waitcnt lgkmcnt(4)
  buffer_store_dwordx4 v[32:35], v8, s[48:51], s75 offen sc1
  s_add_u32 s75, s75, 270336
  s_waitcnt lgkmcnt(2)
  buffer_store_dwordx4 v[36:39], v8, s[48:51], s75 offen sc1
  s_add_u32 s75, s75, 270336
  s_waitcnt lgkmcnt(0)
  buffer_store_dwordx4 v[40:43], v8, s[48:51], s75 offen sc1
  s_sub_u32 s8, s5, 28
  s_mul_i32 s8, s8, 401408
  s_lshl_b32 s10, s74, 13
  s_add_u32 s8, s8, s10
  v_lshlrev_b32 v2, 7, v1
  s_waitcnt vmcnt(0)
  s_barrier
  s_buffer_atomic_swap s64, s[48:51], s9 offset:0
  s_buffer_atomic_swap s64, s[48:51], s9 offset:4352
  s_buffer_atomic_swap s64, s[48:51], s9 offset:8704
  s_buffer_atomic_swap s64, s[48:51], s9 offset:13056
  s_lshl_b32 s8, s2, 3
  s_add_u32 s8, s8, s74
  s_cmp_lg_u32 s8, 2040
  s_cbranch_scc1 L_sp_end
  v_lshrrev_b32 v5, 2, v1
  v_and_b32_e64 v4, 3, v1
  v_lshl_add_u32 v5, v5, 3, v4
  v_lshlrev_b32_e64 v5, 7, v5
  s_mov_b32 s18, 14721024
  s_add_u32 s20, s64, 14
  s_mov_b32 s66, 0x100000
L_close:
  s_sleep 32
  buffer_load_dword v16, v5, s[48:51], s18 offen sc1
  s_waitcnt vmcnt(0)
  v_xor_b32 v16, s20, v16
  v_cmp_ne_u32 vcc, 0, v16
  s_sub_u32 s66, s66, 1
  s_cbranch_scc1 L_closed
  s_cbranch_vccnz L_close
L_closed:
  s_buffer_atomic_swap s64, s[48:51], s11
L_sp_end:
  s_branch L_fin
L_fin:
L_end:
  s_endpgm
DSL_24:
  s_mov_b32 s66, 0x2000000
DLP_23:
  ds_read_b128 v[124:127], v14 offset:28800
  s_waitcnt lgkmcnt(0)
  v_min_u32 v124, v124, v125
  v_min3_u32 v124, v124, v126, v127
  v_cmp_eq_u32_e64 vcc, 0, v124
  s_sub_u32 s66, s66, 1
  s_cbranch_scc1 DOK_22
  s_cbranch_vccnz DLP_23
  s_branch DOK_22
CSL_27:
  s_mov_b32 s66, 0x2000000
CLP_26:
  ds_read_b32 v6, v14 offset:49080
  s_waitcnt lgkmcnt(0)
  v_cmp_gt_u32 vcc, 4, v6
  s_sub_u32 s66, s66, 1
  s_cbranch_scc1 COK_25
  s_cbranch_vccnz CLP_26
  s_branch COK_25
DSL_30:
  s_mov_b32 s66, 0x2000000
DLP_29:
  ds_read_b128 v[124:127], v14 offset:28816
  s_waitcnt lgkmcnt(0)
  v_min_u32 v124, v124, v125
  v_min3_u32 v124, v124, v126, v127
  v_cmp_eq_u32_e64 vcc, 0, v124
  s_sub_u32 s66, s66, 1
  s_cbranch_scc1 DOK_28
  s_cbranch_vccnz DLP_29
  s_branch DOK_28
CSL_33:
  s_mov_b32 s66, 0x2000000
CLP_32:
  ds_read_b32 v6, v14 offset:49080
  s_waitcnt lgkmcnt(0)
  v_cmp_gt_u32 vcc, 8, v6
  s_sub_u32 s66, s66, 1
  s_cbranch_scc1 COK_31
  s_cbranch_vccnz CLP_32
  s_branch COK_31
CSL_45:
  s_mov_b32 s66, 0x2000000
CLP_44:
  ds_read_b32 v6, v14 offset:49056
  s_waitcnt lgkmcnt(0)
  v_cmp_gt_u32 vcc, 4, v6
  s_sub_u32 s66, s66, 1
  s_cbranch_scc1 COK_43
  s_cbranch_vccnz CLP_44
  s_branch COK_43
L_codeend:
.section .rodata,"a"
.p2align 6
.amdhsa_kernel parallel_sum__ssm_conv_s4__dense_activation_squared_relu__prompt_kernel
  .amdhsa_next_free_vgpr 256
  .amdhsa_next_free_sgpr 102
  .amdhsa_accum_offset 128
  .amdhsa_group_segment_fixed_size 0
  .amdhsa_kernarg_size 136
  .amdhsa_user_sgpr_count 2
  .amdhsa_user_sgpr_kernarg_segment_ptr 1
  .amdhsa_system_sgpr_workgroup_id_x 1
.end_amdhsa_kernel
```
